```python
import torch

def _softmax(x, axis=-1):
    return torch.softmax(x, dim=axis)
def _gelu(x):
    return torch.nn.functional.gelu(x, approximate="tanh")
def _silu(x):
    return torch.nn.functional.silu(x)
def _sigmoid(x):
    return torch.sigmoid(x)
def _layernorm(x, axis=-1, eps=1e-5):
    m = x.mean(dim=axis, keepdim=True)
    v = x.var(dim=axis, keepdim=True, unbiased=False)
    return (x - m) / torch.sqrt(v + eps)
def _scatter_add(tgt, idx, src, axis=0):
    return tgt.clone().index_add_(axis, idx, src)
def _segment_sum(src, seg, n):
    out = torch.zeros((n,) + src.shape[1:], dtype=src.dtype)
    return out.index_add_(0, seg, src)
def _pad(x, pw):
    flat = tuple(v for pair in reversed(pw) for v in pair)
    return torch.nn.functional.pad(x, flat)

kernel_name = 'parallel_sum__sliding_local_dilated__glu_gated_swiglu__prompt'

def setup_inputs():

    _w = (lambda a: (lambda t: t.to(torch.bfloat16) if t.is_floating_point() else t)(torch.as_tensor(a)))
    def _A_setup():
        B, S, D = 1, 2048, 512
        return {
            "x": _w((lambda *s: torch.randn(*s, dtype=torch.bfloat16) * 0.05)(B, S, D)),
            "wqkv": _w((lambda *s: torch.randn(*s, dtype=torch.bfloat16) * 0.05)(D, 3 * D)),
            "wo": _w((lambda *s: torch.randn(*s, dtype=torch.bfloat16) * 0.05)(D, D)),
        }
    _A_in = _A_setup()

    def _B_setup():
        B, S, D, F = 1, 2048, 512, 1792
        return {
            "x": _w((lambda *s: torch.randn(*s, dtype=torch.bfloat16) * 0.05)(B, S, D)),
            "w1": _w((lambda *s: torch.randn(*s, dtype=torch.bfloat16) * 0.8)(D, F) * (2.0 / D) ** 0.5),
            "w3": _w((lambda *s: torch.randn(*s, dtype=torch.bfloat16) * 0.8)(D, F) * (2.0 / D) ** 0.5),
            "w2": _w((lambda *s: torch.randn(*s, dtype=torch.bfloat16) * 0.8)(F, D) * (2.0 / F) ** 0.5),
        }
    _B_in = _B_setup()

    return {
        "A_x": _A_in["x"],
        "A_wqkv": _A_in["wqkv"],
        "A_wo": _A_in["wo"],
        "B_x": _B_in["x"],
        "B_w1": _B_in["w1"],
        "B_w3": _B_in["w3"],
        "B_w2": _B_in["w2"],
    }

def reference(A_x, A_wqkv, A_wo, B_x, B_w1, B_w3, B_w2):
    def _A_ref(x, wqkv, wo):
        B, S, D = x.shape
        H = 32; Dh = D // H
        W, dil = 8, 2
        qkv = (lambda x, *d: x.permute(*d))((x @ wqkv).reshape(B, S, 3, H, Dh), 2, 0, 3, 1, 4)
        q, k, v = qkv[0], qkv[1], qkv[2]
        scale = Dh ** -0.5
        pos = torch.arange(S)
        off = torch.arange(W) * dil
        idx = pos[:, None] - off[None, :]
        mask = idx >= 0
        idx_c = torch.where(mask, idx, 0).reshape(-1)
        kg = k[:, :, idx_c, :].reshape(B, H, S, W, Dh)
        vg = v[:, :, idx_c, :].reshape(B, H, S, W, Dh)
        logits = torch.einsum("bhsd,bhswd->bhsw", q, kg) * scale
        logits = torch.where(mask[None, None, :, :], logits, -1e9)
        attn = _softmax(logits, axis=-1)
        o = torch.einsum("bhsw,bhswd->bhsd", attn, vg)
        return (lambda x, *d: x.permute(*d))(o, 0, 2, 1, 3).reshape(B, S, D) @ wo

    def _B_ref(x, w1, w3, w2):
        gate = torch.einsum("bsd,df->bsf", x, w1)
        up = torch.einsum("bsd,df->bsf", x, w3)
        h = _silu(gate) * up
        out = torch.einsum("bsf,fd->bsd", h, w2)
        return out

    x = A_x
    xn = _layernorm(x, axis=-1)
    return x + _A_ref(xn, A_wqkv, A_wo) + _B_ref(xn, B_w1, B_w3, B_w2)
```

```asm
; @launch grid=(256,1,1) block=(512,1,1) lds=163840
.amdgcn_target "amdgcn-amd-amdhsa--gfx950"
.text
.globl parallel_sum__sliding_local_dilated__glu_gated_swiglu__prompt_kernel
.p2align 8
.type parallel_sum__sliding_local_dilated__glu_gated_swiglu__prompt_kernel,@function
parallel_sum__sliding_local_dilated__glu_gated_swiglu__prompt_kernel:
s_cmp_ge_u32 s2, 256
s_cbranch_scc1 L_end
s_load_dwordx2 s[4:5], s[0:1], 0
s_load_dwordx2 s[8:9], s[0:1], 8
s_load_dwordx4 s[64:67], s[0:1], 32
L_pcT:
s_getpc_b64 s[98:99]
s_lshr_b32 s3, s2, 3
v_and_b32 v24, 31, v0
v_lshlrev_b32 v252, 7, v0
v_cmp_eq_u32 vcc, s3, v24
v_min_u32 v252, 0x9a00, v252
s_mov_b64 exec, vcc
global_load_dword v252, v252, s[98:99]
s_mov_b64 exec, -1
s_memrealtime s[40:41]
s_mov_b32 s6, 0x200000
s_mov_b32 s7, 0x20000
s_lshl_b32 s58, s2, 13
v_lshlrev_b32 v23, 4, v0
v_lshrrev_b32 v24, 6, v0
v_and_b32 v1, 63, v0
v_readfirstlane_b32 s42, v24
v_lshlrev_b32 v1, 4, v1
s_and_b32 s47, s2, 3
s_bfe_u32 s57, s2, 0x10002
s_bfe_u32 s45, s2, 0x30003
s_lshl3_add_u32 s45, s57, s45
s_lshr_b32 s48, s2, 6
s_lshr_b32 s77, s2, 6
s_mov_b32 s68, 0
s_and_b32 s89, s47, 1
s_and_b32 s43, s42, 3
s_lshr_b32 s44, s42, 2
s_lshl_b32 s49, s42, 11
s_lshl1_add_u32 s50, s43, s44
s_lshl_b32 s50, s50, 11
s_lshl2_add_u32 s59, s45, s43
s_lshl_b32 s51, s59, 5
s_xor_b32 s57, s44, s89
s_add_u32 s51, s51, s57
s_lshl_b32 s51, s51, 10
v_lshrrev_b32 v24, 7, v1
v_lshrrev_b32 v25, 4, v1
v_and_b32 v25, 0x30, v25
v_xor_b32 v25, v25, v1
v_and_b32 v25, 0x70, v25
v_lshl_add_u32 v20, v24, 11, v25
v_xor_b32 v21, 64, v20
v_add_u32 v21, 0x3c00, v21
s_mov_b32 m0, s50
s_lshl1_add_u32 s46, s68, s51
s_waitcnt lgkmcnt(0)
buffer_load_dwordx4 v20, s[4:7], s46 offen lds
buffer_load_dwordx4 v21, s[4:7], s46 offen offset:1024 lds
s_load_dwordx2 s[80:81], s[0:1], 64
s_load_dwordx2 s[24:25], s[0:1], 72
s_load_dwordx2 s[20:21], s[0:1], 16
s_load_dwordx2 s[16:17], s[0:1], 48
s_load_dwordx2 s[28:29], s[0:1], 56
s_and_b32 s57, s43, 1
s_lshr_b32 s58, s43, 1
s_lshl2_add_u32 s57, s57, s58
s_lshl_b32 s57, s57, 2
v_and_b32 v26, 4, v24
v_add3_u32 v26, v26, v24, s57
v_lshrrev_b32 v27, 3, v1
v_and_b32 v27, 0x60, v27
v_xor_b32 v27, v27, v1
v_and_b32 v27, 0x70, v27
s_mov_b32 s10, 0x180000
s_mov_b32 s11, 0x20000
s_mov_b32 s14, 0x1c0000
s_mov_b32 s15, 0x20000
s_cmp_lt_u32 s48, 2
s_cbranch_scc0 L_F
s_lshl1_add_u32 s85, s47, s48
s_lshl_b32 s54, s85, 7
s_lshl_b32 s57, s44, 10
s_add_u32 s52, s54, s57
s_add_u32 s52, s52, 1024
v_mul_u32_u24 v4, 3072, v26
v_add_u32 v4, v4, v27
s_add_u32 m0, s49, 0x4000
s_mul_i32 s46, s68, 3072
s_add_u32 s46, s46, s52
buffer_load_dwordx4 v4, s[8:11], s46 offen offset:0 lds
s_add_u32 s46, s46, 0x17c00
buffer_load_dwordx4 v4, s[8:11], s46 offen offset:1024 lds
s_lshl_b32 s96, s77, 1
s_and_b32 s69, s45, 7
s_add_u32 s96, s96, s69
s_sub_u32 s69, s96, 7
s_cmp_ge_u32 s96, 7
s_cselect_b32 s96, s69, s96
s_lshl_b32 s96, s96, 6
s_add_u32 s69, s96, 64
s_lshl_b32 s57, s44, 6
v_lshrrev_b32 v2, 2, v1
v_xor_b32 v2, s57, v2
v_and_b32 v2, 0x60, v2
v_bfe_u32 v25, v1, 4, 2
v_lshl_add_u32 v2, v25, 3, v2
v_bfe_u32 v25, v1, 6, 3
v_lshl_add_u32 v2, v25, 7, v2
v_lshrrev_b32 v25, 9, v1
v_lshl_add_u32 v2, v25, 11, v2
v_xor_b32 v3, 32, v2
v_lshrrev_b32 v253, 8, v1
v_bfe_u32 v25, v1, 5, 3
v_xor_b32 v25, v253, v25
s_lshl_b32 s57, s43, 12
v_lshl_add_u32 v25, v25, 4, s57
v_and_b32 v23, 0xf0, v1
v_lshl_add_u32 v18, v23, 3, v25
v_xor_b32 v19, 64, v18
v_mul_u32_u24 v5, 3584, v26
v_add_u32 v5, v5, v27
s_cmp_eq_u32 s44, 0
s_cselect_b64 s[12:13], s[64:65], s[66:67]
s_mul_i32 s53, s47, 7
s_add_u32 s53, s53, s48
s_lshl_b32 s53, s53, 7
s_add_u32 m0, s49, 0x8000
s_mul_i32 s46, s68, 3584
s_add_u32 s46, s46, s53
buffer_load_dwordx4 v5, s[12:15], s46 offen offset:0 lds
s_add_u32 s46, s46, 0x1bc00
buffer_load_dwordx4 v5, s[12:15], s46 offen offset:1024 lds
s_waitcnt lgkmcnt(0)
s_or_b32 s57, s2, s42
s_cmp_eq_u32 s57, 0
s_cbranch_scc0 L_if1
s_or_b32 s40, s40, 1
v_mov_b32 v254, s40
s_mov_b64 exec, 1
global_store_dword v1, v254, s[80:81] sc1
s_mov_b64 exec, -1
L_if1:
s_add_u32 s70, s69, 64
s_cmp_ge_u32 s70, 512
s_cselect_b32 s70, 64, s70
s_add_u32 s71, s70, 64
s_cmp_ge_u32 s71, 512
s_cselect_b32 s71, 64, s71
s_add_u32 s72, s71, 64
s_cmp_ge_u32 s72, 512
s_cselect_b32 s72, 64, s72
s_add_u32 s73, s72, 64
s_cmp_ge_u32 s73, 512
s_cselect_b32 s73, 64, s73
s_add_u32 s74, s73, 64
s_cmp_ge_u32 s74, 512
s_cselect_b32 s74, 64, s74
s_add_u32 s75, s74, 64
s_cmp_ge_u32 s75, 512
s_cselect_b32 s75, 64, s75
s_lshl_b32 s58, s43, 12
s_add_u32 s58, s58, 0x23000
v_bfe_u32 v16, v1, 6, 1
v_lshrrev_b32 v15, 9, v1
v_lshl_add_u32 v16, v15, 1, v16
v_lshlrev_b32 v16, 3, v16
v_xor_b32 v15, v2, v16
v_add_u32 v15, s58, v15
v_xor_b32 v16, 32, v15
v_and_b32 v17, 0x70, v4
v_lshrrev_b32 v25, 7, v1
v_lshl_add_u32 v17, v25, 10, v17
v_mov_b32 v22, 0
v_lshrrev_b32 v9, 2, v1
s_lshl2_add_u32 s62, s47, s48
s_lshl4_add_u32 s88, s45, s62
s_lshl3_add_u32 s88, s88, s42
v_lshl_add_u32 v241, v253, 10, v23
v_lshrrev_b32 v25, 1, v253
v_lshlrev_b32 v25, 6, v25
v_lshrrev_b32 v6, 2, v23
s_mul_i32 s58, s44, 640
s_add_u32 s58, s58, 0x20000
v_add3_u32 v6, v6, v25, s58
v_lshrrev_b32 v25, 4, v25
v_lshrrev_b32 v240, 1, v23
s_lshl_b32 s57, s43, 7
s_add_u32 s57, s57, s58
v_add3_u32 v240, v240, v25, s57
v_xor_b32 v253, s89, v253
v_and_b32 v253, 1, v253
v_lshlrev_b32 v253, 4, v253
v_lshl_add_u32 v23, v23, 1, v253
s_mov_b32 s26, 0x1800000
s_mov_b32 s27, 0x20000
s_mov_b32 s18, 0x1c0000
s_mov_b32 s19, 0x20000
s_mov_b32 s22, 0x80000
s_mov_b32 s23, 0x20000
s_mov_b32 s30, 0x200000
s_mov_b32 s31, 0x20000
s_mul_i32 s62, s62, 96
s_add_u32 s62, s62, s44
s_lshl_b32 s62, s62, 8
s_add_u32 s62, s62, 0xb10000
s_and_b32 s57, s43, 1
s_lshr_b32 s58, s43, 1
s_lshl_b32 s82, s57, 5
s_lshl_b32 s83, s58, 13
s_lshl2_add_u32 s58, s58, s57
s_lshl_b32 s58, s58, 7
s_add_u32 s61, s62, s58
s_lshl_b32 s57, s57, 9
s_add_u32 s62, s62, s57
s_lshr_b32 s97, s45, 3
s_and_b32 s76, s45, 7
s_sub_u32 s76, s76, 7
s_min_u32 s76, s76, 1
v_xor_b32 v237, s82, v2
v_add_u32 v236, s83, v237
v_mov_b32 v224, 0x3f803f80
v_mov_b32 v225, 0x3f803f80
v_mov_b32 v226, 0x3f803f80
v_mov_b32 v227, 0x3f803f80
s_barrier
s_add_u32 m0, s50, 0xc000
s_lshl1_add_u32 s46, s69, s51
buffer_load_dwordx4 v20, s[4:7], s46 offen offset:0 lds
buffer_load_dwordx4 v21, s[4:7], s46 offen offset:1024 lds
s_barrier
s_add_u32 m0, s49, 0x10000
s_mul_i32 s46, s69, 3072
s_add_u32 s46, s46, s52
buffer_load_dwordx4 v4, s[8:11], s46 offen offset:0 lds
s_add_u32 s46, s46, 0x17c00
buffer_load_dwordx4 v4, s[8:11], s46 offen offset:1024 lds
s_waitcnt vmcnt(6)
s_barrier
ds_read_b128 v[144:147], v18 offset:0
ds_read_b128 v[148:151], v18 offset:2048
ds_read_b64_tr_b16 v[32:33], v2 offset:16384
ds_read_b64_tr_b16 v[34:35], v2 offset:20480
ds_read_b64_tr_b16 v[36:37], v3 offset:16384
ds_read_b64_tr_b16 v[38:39], v3 offset:20480
ds_read_b64_tr_b16 v[40:41], v2 offset:24576
ds_read_b64_tr_b16 v[42:43], v2 offset:28672
ds_read_b64_tr_b16 v[44:45], v3 offset:24576
ds_read_b64_tr_b16 v[46:47], v3 offset:28672
s_setprio 0
s_waitcnt lgkmcnt(6)
v_mfma_f32_16x16x32_bf16 v[96:99], v[32:35], v[144:147], 0
ds_read_b128 v[152:155], v19 offset:0
ds_read_b128 v[156:159], v19 offset:2048
v_mfma_f32_16x16x32_bf16 v[100:103], v[32:35], v[148:151], 0
ds_read_b64_tr_b16 v[48:49], v2 offset:17408
ds_read_b64_tr_b16 v[50:51], v2 offset:21504
s_waitcnt lgkmcnt(8)
v_mfma_f32_16x16x32_bf16 v[104:107], v[36:39], v[144:147], 0
ds_read_b64_tr_b16 v[52:53], v3 offset:17408
ds_read_b64_tr_b16 v[54:55], v3 offset:21504
v_mfma_f32_16x16x32_bf16 v[108:111], v[36:39], v[148:151], 0
ds_read_b64_tr_b16 v[56:57], v2 offset:25600
ds_read_b64_tr_b16 v[58:59], v2 offset:29696
s_waitcnt lgkmcnt(10)
v_mfma_f32_16x16x32_bf16 v[112:115], v[40:43], v[144:147], 0
ds_read_b64_tr_b16 v[60:61], v3 offset:25600
ds_read_b64_tr_b16 v[62:63], v3 offset:29696
s_lshl_b32 s63, s59, 9
s_add_u32 s63, s63, 0xb00000
s_lshl2_add_u32 s59, s59, s47
s_mul_i32 s60, s59, 20
s_mul_i32 s59, s59, 36864
s_and_b32 s57, s48, 1
s_lshl1_add_u32 s57, s57, s44
s_add_u32 s60, s57, s60
s_lshl_b32 s60, s60, 7
s_add_u32 s60, s60, 0xc00000
s_lshl_b32 s57, s57, 10
s_add_u32 s86, s59, s57
s_add_u32 s59, s86, s57
v_mfma_f32_16x16x32_bf16 v[116:119], v[40:43], v[148:151], 0
s_lshr_b32 s57, s2, 5
s_lshl_b32 s57, s57, 7
s_lshl_b32 s58, s43, 13
s_add_u32 s57, s57, s58
s_bfe_u32 s3, s2, 0x10001
s_xor_b32 s3, s3, 1
s_lshl1_add_u32 s58, s3, s44
s_mul_i32 s55, s58, 458752
s_add_u32 s55, s55, s57
s_lshl_b32 s56, s58, 17
s_add_u32 s56, s56, s57
s_cmp_eq_u32 s43, 3
s_cselect_b32 s94, 0, 0xff00ff00
s_mov_b32 s95, s94
s_waitcnt lgkmcnt(10)
v_mfma_f32_16x16x32_bf16 v[120:123], v[44:47], v[144:147], 0
s_add_u32 m0, s49, 0x14000
s_mul_i32 s46, s69, 3584
s_add_u32 s46, s46, s53
buffer_load_dwordx4 v5, s[12:15], s46 offen offset:0 lds
s_add_u32 s46, s46, 0x1bc00
buffer_load_dwordx4 v5, s[12:15], s46 offen offset:1024 lds
s_lshl3_add_u32 s85, s45, s85
s_lshl1_add_u32 s85, s85, s44
s_lshl_b32 s86, s85, 8
s_add_u32 s86, s86, 0xcc0000
s_lshl_b32 s85, s85, 12
s_add_u32 s85, s85, 0xa00000
s_mov_b64 s[36:37], s[24:25]
s_cmp_lg_u32 s45, 0
s_cselect_b32 s38, 0x1800000, 0
s_mov_b32 s39, 0x20000
v_mfma_f32_16x16x32_bf16 v[124:127], v[44:47], v[148:151], 0
s_bfe_u32 s58, s2, 0x10002
s_xor_b32 s58, s58, 0
s_and_b32 s57, s2, 1
s_lshl1_add_u32 s58, s58, s57
s_bfe_u32 s57, s2, 0x20003
s_lshl2_add_u32 s58, s58, s57
s_lshl2_add_u32 s58, s58, s43
s_lshl_b32 s91, s58, 5
s_lshl1_add_u32 s58, s58, s3
s_lshl1_add_u32 s58, s58, s44
s_mul_i32 s90, s58, 36864
s_mul_i32 s92, s58, 2560
s_add_u32 s92, s92, 0xc00000
s_lshr_b32 s58, s2, 5
s_add_u32 s91, s91, s44
s_lshl3_add_u32 s91, s91, s58
s_lshl1_add_u32 s91, s91, s3
s_lshl_b32 s91, s91, 6
s_lshl3_add_u32 s93, s2, s42
s_lshl_b32 s93, s93, 12
s_waitcnt vmcnt(6) lgkmcnt(0)
s_barrier
s_setprio 1
v_mfma_f32_16x16x32_bf16 v[96:99], v[48:51], v[152:155], v[96:99]
ds_read_b64_tr_b16 v[32:33], v2 offset:32768
ds_read_b64_tr_b16 v[34:35], v2 offset:36864
v_mfma_f32_16x16x32_bf16 v[100:103], v[48:51], v[156:159], v[100:103]
ds_read_b64_tr_b16 v[36:37], v3 offset:32768
ds_read_b64_tr_b16 v[38:39], v3 offset:36864
v_mfma_f32_16x16x32_bf16 v[104:107], v[52:55], v[152:155], v[104:107]
ds_read_b64_tr_b16 v[40:41], v2 offset:40960
ds_read_b64_tr_b16 v[42:43], v2 offset:45056
v_mfma_f32_16x16x32_bf16 v[108:111], v[52:55], v[156:159], v[108:111]
ds_read_b64_tr_b16 v[44:45], v3 offset:40960
ds_read_b64_tr_b16 v[46:47], v3 offset:45056
v_mfma_f32_16x16x32_bf16 v[112:115], v[56:59], v[152:155], v[112:115]
s_cmp_eq_u32 s76, 0
s_cbranch_scc0 L_if34
s_mov_b32 s58, 0x8000
s_cmp_eq_u32 s97, 0
s_cselect_b32 s58, 0x4000, s58
v_add_u32 v236, s58, v236
s_lshl4_add_u32 s61, s68, s61
ds_read_b64_tr_b16 v[208:209], v236 offset:0
ds_read_b64_tr_b16 v[210:211], v236 offset:4096
ds_read_b64_tr_b16 v[212:213], v236 offset:1024
ds_read_b64_tr_b16 v[214:215], v236 offset:5120
L_if34:
v_mfma_f32_16x16x32_bf16 v[116:119], v[56:59], v[156:159], v[116:119]
v_mfma_f32_16x16x32_bf16 v[120:123], v[60:63], v[152:155], v[120:123]
v_mfma_f32_16x16x32_bf16 v[124:127], v[60:63], v[156:159], v[124:127]
s_setprio 0
s_waitcnt lgkmcnt(0)
v_mfma_f32_16x16x32_bf16 v[64:67], v[32:35], v[144:147], 0
ds_read_b64_tr_b16 v[48:49], v2 offset:33792
ds_read_b64_tr_b16 v[50:51], v2 offset:37888
v_mfma_f32_16x16x32_bf16 v[68:71], v[32:35], v[148:151], 0
ds_read_b64_tr_b16 v[52:53], v3 offset:33792
ds_read_b64_tr_b16 v[54:55], v3 offset:37888
v_mfma_f32_16x16x32_bf16 v[72:75], v[36:39], v[144:147], 0
ds_read_b64_tr_b16 v[56:57], v2 offset:41984
ds_read_b64_tr_b16 v[58:59], v2 offset:46080
v_mfma_f32_16x16x32_bf16 v[76:79], v[36:39], v[148:151], 0
ds_read_b64_tr_b16 v[60:61], v3 offset:41984
ds_read_b64_tr_b16 v[62:63], v3 offset:46080
v_mfma_f32_16x16x32_bf16 v[80:83], v[40:43], v[144:147], 0
v_mfma_f32_16x16x32_bf16 v[84:87], v[40:43], v[148:151], 0
v_mfma_f32_16x16x32_bf16 v[88:91], v[44:47], v[144:147], 0
s_add_u32 m0, s49, 0x18000
s_cmp_eq_u32 s44, 0
s_cselect_b32 s46, s68, s69
s_mul_i32 s46, s46, 3072
s_add_u32 s46, s46, s54
buffer_load_dwordx4 v4, s[8:11], s46 offen offset:0 lds
s_add_u32 s46, s46, 0x17c00
buffer_load_dwordx4 v4, s[8:11], s46 offen offset:1024 lds
v_mfma_f32_16x16x32_bf16 v[92:95], v[44:47], v[148:151], 0
s_waitcnt vmcnt(4) lgkmcnt(0)
s_barrier
s_setprio 1
v_mfma_f32_16x16x32_bf16 v[64:67], v[48:51], v[152:155], v[64:67]
ds_read_b128 v[160:163], v18 offset:49152
ds_read_b128 v[164:167], v18 offset:51200
v_mfma_f32_16x16x32_bf16 v[68:71], v[48:51], v[156:159], v[68:71]
v_add_u32 v2, 0x10000, v2
ds_read_b64_tr_b16 v[32:33], v2 offset:0
ds_read_b64_tr_b16 v[34:35], v2 offset:4096
v_mfma_f32_16x16x32_bf16 v[72:75], v[52:55], v[152:155], v[72:75]
v_add_u32 v3, 0x10000, v3
ds_read_b64_tr_b16 v[36:37], v3 offset:0
ds_read_b64_tr_b16 v[38:39], v3 offset:4096
v_mfma_f32_16x16x32_bf16 v[76:79], v[52:55], v[156:159], v[76:79]
ds_read_b64_tr_b16 v[40:41], v2 offset:8192
ds_read_b64_tr_b16 v[42:43], v2 offset:12288
v_mfma_f32_16x16x32_bf16 v[80:83], v[56:59], v[152:155], v[80:83]
ds_read_b64_tr_b16 v[44:45], v3 offset:8192
ds_read_b64_tr_b16 v[46:47], v3 offset:12288
v_mfma_f32_16x16x32_bf16 v[84:87], v[56:59], v[156:159], v[84:87]
v_mfma_f32_16x16x32_bf16 v[88:91], v[60:63], v[152:155], v[88:91]
v_mfma_f32_16x16x32_bf16 v[92:95], v[60:63], v[156:159], v[92:95]
s_setprio 0
s_waitcnt lgkmcnt(0)
v_mfma_f32_16x16x32_bf16 v[96:99], v[32:35], v[160:163], v[96:99]
ds_read_b128 v[168:171], v19 offset:49152
ds_read_b128 v[172:175], v19 offset:51200
v_mfma_f32_16x16x32_bf16 v[100:103], v[32:35], v[164:167], v[100:103]
ds_read_b64_tr_b16 v[48:49], v2 offset:1024
ds_read_b64_tr_b16 v[50:51], v2 offset:5120
v_mfma_f32_16x16x32_bf16 v[104:107], v[36:39], v[160:163], v[104:107]
ds_read_b64_tr_b16 v[52:53], v3 offset:1024
ds_read_b64_tr_b16 v[54:55], v3 offset:5120
v_mfma_f32_16x16x32_bf16 v[108:111], v[36:39], v[164:167], v[108:111]
ds_read_b64_tr_b16 v[56:57], v2 offset:9216
ds_read_b64_tr_b16 v[58:59], v2 offset:13312
v_mfma_f32_16x16x32_bf16 v[112:115], v[40:43], v[160:163], v[112:115]
ds_read_b64_tr_b16 v[60:61], v3 offset:9216
ds_read_b64_tr_b16 v[62:63], v3 offset:13312
s_add_u32 m0, s50, 0x1c000
s_lshl1_add_u32 s46, s70, s51
buffer_load_dwordx4 v20, s[4:7], s46 offen offset:0 lds
buffer_load_dwordx4 v21, s[4:7], s46 offen offset:1024 lds
v_mfma_f32_16x16x32_bf16 v[116:119], v[40:43], v[164:167], v[116:119]
global_load_dword v8, v22, s[80:81] sc1
v_mfma_f32_16x16x32_bf16 v[120:123], v[44:47], v[160:163], v[120:123]
v_mfma_f32_16x16x32_bf16 v[124:127], v[44:47], v[164:167], v[124:127]
s_waitcnt vmcnt(5) lgkmcnt(0)
s_barrier
s_setprio 1
v_mfma_f32_16x16x32_bf16 v[96:99], v[48:51], v[168:171], v[96:99]
ds_read_b64_tr_b16 v[32:33], v2 offset:16384
ds_read_b64_tr_b16 v[34:35], v2 offset:20480
v_mfma_f32_16x16x32_bf16 v[100:103], v[48:51], v[172:175], v[100:103]
ds_read_b64_tr_b16 v[36:37], v3 offset:16384
ds_read_b64_tr_b16 v[38:39], v3 offset:20480
v_mfma_f32_16x16x32_bf16 v[104:107], v[52:55], v[168:171], v[104:107]
ds_read_b64_tr_b16 v[40:41], v2 offset:24576
ds_read_b64_tr_b16 v[42:43], v2 offset:28672
v_mfma_f32_16x16x32_bf16 v[108:111], v[52:55], v[172:175], v[108:111]
ds_read_b64_tr_b16 v[44:45], v3 offset:24576
ds_read_b64_tr_b16 v[46:47], v3 offset:28672
v_mfma_f32_16x16x32_bf16 v[112:115], v[56:59], v[168:171], v[112:115]
s_cmp_eq_u32 s76, 1
s_cbranch_scc0 L_if36
s_mov_b32 s58, 0x14000
s_cmp_eq_u32 s97, 0
s_cselect_b32 s58, 0x10000, s58
v_add_u32 v236, s58, v236
s_lshl4_add_u32 s61, s69, s61
ds_read_b64_tr_b16 v[208:209], v236 offset:0
ds_read_b64_tr_b16 v[210:211], v236 offset:4096
ds_read_b64_tr_b16 v[212:213], v236 offset:1024
ds_read_b64_tr_b16 v[214:215], v236 offset:5120
L_if36:
v_mfma_f32_16x16x32_bf16 v[116:119], v[56:59], v[172:175], v[116:119]
v_mfma_f32_16x16x32_bf16 v[120:123], v[60:63], v[168:171], v[120:123]
v_mfma_f32_16x16x32_bf16 v[124:127], v[60:63], v[172:175], v[124:127]
s_setprio 0
s_waitcnt lgkmcnt(0)
v_mfma_f32_16x16x32_bf16 v[64:67], v[32:35], v[160:163], v[64:67]
ds_read_b64_tr_b16 v[48:49], v2 offset:17408
ds_read_b64_tr_b16 v[50:51], v2 offset:21504
s_add_u32 m0, s49, 0x24000
s_mul_i32 s46, s70, 3072
s_add_u32 s46, s46, s52
buffer_load_dwordx4 v4, s[8:11], s46 offen offset:0 lds
s_add_u32 s46, s46, 0x17c00
buffer_load_dwordx4 v4, s[8:11], s46 offen offset:1024 lds
v_mfma_f32_16x16x32_bf16 v[68:71], v[32:35], v[164:167], v[68:71]
ds_read_b64_tr_b16 v[52:53], v3 offset:17408
ds_read_b64_tr_b16 v[54:55], v3 offset:21504
s_lshl_b32 s58, s88, 10
buffer_load_dwordx4 v[28:31], v1, s[4:7], s58 offen
v_mfma_f32_16x16x32_bf16 v[72:75], v[36:39], v[160:163], v[72:75]
ds_read_b64_tr_b16 v[56:57], v2 offset:25600
ds_read_b64_tr_b16 v[58:59], v2 offset:29696
v_mfma_f32_16x16x32_bf16 v[76:79], v[36:39], v[164:167], v[76:79]
ds_read_b64_tr_b16 v[60:61], v3 offset:25600
ds_read_b64_tr_b16 v[62:63], v3 offset:29696
v_mfma_f32_16x16x32_bf16 v[80:83], v[40:43], v[160:163], v[80:83]
s_add_u32 m0, s49, 0x0
s_mul_i32 s46, s70, 3584
s_add_u32 s46, s46, s53
buffer_load_dwordx4 v5, s[12:15], s46 offen offset:0 lds
v_mfma_f32_16x16x32_bf16 v[84:87], v[40:43], v[164:167], v[84:87]
v_mfma_f32_16x16x32_bf16 v[88:91], v[44:47], v[160:163], v[88:91]
v_mfma_f32_16x16x32_bf16 v[92:95], v[44:47], v[164:167], v[92:95]
s_waitcnt vmcnt(7) lgkmcnt(0)
s_barrier
s_setprio 1
v_mfma_f32_16x16x32_bf16 v[64:67], v[48:51], v[168:171], v[64:67]
ds_read_b64_tr_b16 v[32:33], v2 offset:32768
ds_read_b64_tr_b16 v[34:35], v2 offset:36864
s_add_u32 s46, s46, 0x1bc00
buffer_load_dwordx4 v5, s[12:15], s46 offen offset:1024 lds
v_mfma_f32_16x16x32_bf16 v[68:71], v[48:51], v[172:175], v[68:71]
ds_read_b64_tr_b16 v[36:37], v3 offset:32768
ds_read_b64_tr_b16 v[38:39], v3 offset:36864
s_add_u32 m0, s49, 0x4000
s_cmp_eq_u32 s44, 0
s_cselect_b32 s46, s70, s71
s_mul_i32 s46, s46, 3072
s_add_u32 s46, s46, s54
buffer_load_dwordx4 v4, s[8:11], s46 offen offset:0 lds
v_mfma_f32_16x16x32_bf16 v[72:75], v[52:55], v[168:171], v[72:75]
ds_read_b64_tr_b16 v[40:41], v2 offset:33792
ds_read_b64_tr_b16 v[42:43], v2 offset:37888
v_mfma_f32_16x16x32_bf16 v[76:79], v[52:55], v[172:175], v[76:79]
ds_read_b64_tr_b16 v[44:45], v3 offset:33792
ds_read_b64_tr_b16 v[46:47], v3 offset:37888
v_mfma_f32_16x16x32_bf16 v[80:83], v[56:59], v[168:171], v[80:83]
s_add_u32 s46, s46, 0x17c00
buffer_load_dwordx4 v4, s[8:11], s46 offen offset:1024 lds
s_cmp_eq_u32 s76, 0
s_cbranch_scc0 L_if35
v_add_u32 v237, 0x18000, v237
ds_read_b64_tr_b16 v[216:217], v237 offset:0
ds_read_b64_tr_b16 v[218:219], v237 offset:4096
ds_read_b64_tr_b16 v[220:221], v237 offset:1024
ds_read_b64_tr_b16 v[222:223], v237 offset:5120
L_if35:
s_cmp_eq_u32 s76, 1
s_cbranch_scc0 L_if37
v_add_u32 v237, 0x1a000, v237
ds_read_b64_tr_b16 v[216:217], v237 offset:0
ds_read_b64_tr_b16 v[218:219], v237 offset:4096
ds_read_b64_tr_b16 v[220:221], v237 offset:1024
ds_read_b64_tr_b16 v[222:223], v237 offset:5120
L_if37:
v_mfma_f32_16x16x32_bf16 v[84:87], v[56:59], v[172:175], v[84:87]
v_mfma_f32_16x16x32_bf16 v[88:91], v[60:63], v[168:171], v[88:91]
v_mfma_f32_16x16x32_bf16 v[92:95], v[60:63], v[172:175], v[92:95]
s_setprio 0
s_waitcnt lgkmcnt(0)
v_mfma_f32_16x16x32_bf16 v[128:131], v[32:35], v[144:147], 0
ds_read_b64_tr_b16 v[48:49], v2 offset:40960
ds_read_b64_tr_b16 v[50:51], v2 offset:45056
v_mfma_f32_16x16x32_bf16 v[228:231], v[224:227], v[208:211], 0
v_mfma_f32_16x16x32_bf16 v[132:135], v[32:35], v[148:151], 0
ds_read_b64_tr_b16 v[52:53], v3 offset:40960
ds_read_b64_tr_b16 v[54:55], v3 offset:45056
s_add_u32 m0, s50, 0x8000
s_lshl1_add_u32 s46, s71, s51
buffer_load_dwordx4 v20, s[4:7], s46 offen offset:0 lds
v_mfma_f32_16x16x32_bf16 v[228:231], v[224:227], v[212:215], v[228:231]
v_mfma_f32_16x16x32_bf16 v[136:139], v[36:39], v[144:147], 0
ds_read_b64_tr_b16 v[56:57], v2 offset:41984
ds_read_b64_tr_b16 v[58:59], v2 offset:46080
s_waitcnt lgkmcnt(6)
v_mfma_f32_16x16x32_bf16 v[232:235], v[224:227], v[216:219], 0
v_mfma_f32_16x16x32_bf16 v[140:143], v[36:39], v[148:151], 0
ds_read_b64_tr_b16 v[60:61], v3 offset:41984
ds_read_b64_tr_b16 v[62:63], v3 offset:46080
buffer_load_dwordx4 v21, s[4:7], s46 offen offset:1024 lds
s_waitcnt lgkmcnt(8)
v_mfma_f32_16x16x32_bf16 v[232:235], v[224:227], v[220:223], v[232:235]
v_mfma_f32_16x16x32_bf16 v[128:131], v[40:43], v[152:155], v[128:131]
s_waitcnt vmcnt(9)
v_cmp_eq_u32 vcc, 0, v8
s_cbranch_vccnz L_slow38
L_back39:
v_mfma_f32_16x16x32_bf16 v[132:135], v[40:43], v[156:159], v[132:135]
s_add_u32 m0, s49, 0xc000
s_mul_i32 s46, s71, 3072
s_add_u32 s46, s46, s52
buffer_load_dwordx4 v4, s[8:11], s46 offen offset:0 lds
v_lshrrev_b32 v238, 1, v1
v_mfma_f32_16x16x32_bf16 v[136:139], v[44:47], v[152:155], v[136:139]
v_mov_b32 v229, v8
v_mfma_f32_16x16x32_bf16 v[140:143], v[44:47], v[156:159], v[140:143]
v_mov_b32 v233, v8
s_waitcnt vmcnt(3) lgkmcnt(0)
s_barrier
s_setprio 3
v_mfma_f32_16x16x32_bf16 v[128:131], v[48:51], v[160:163], v[128:131]
v_add_u32 v18, 0x10000, v18
ds_read_b128 v[176:179], v18 offset:49152
ds_read_b128 v[180:183], v18 offset:51200
s_add_u32 s46, s46, 0x17c00
buffer_load_dwordx4 v4, s[8:11], s46 offen offset:1024 lds
s_lshl_b32 s58, s97, 13
s_add_u32 s58, s58, s61
s_mov_b64 exec, 0xffff
buffer_store_dwordx2 v[228:229], v238, s[24:27], s58 offen sc1
s_mov_b64 exec, -1
v_mfma_f32_16x16x32_bf16 v[132:135], v[48:51], v[164:167], v[132:135]
v_add_u32 v2, 0x10000, v2
ds_read_b64_tr_b16 v[32:33], v2 offset:16384
ds_read_b64_tr_b16 v[34:35], v2 offset:20480
s_lshr_b32 s57, s43, 1
s_or_b32 s57, s97, s57
s_cmp_eq_u32 s57, 0
s_cbranch_scc0 L_if41
s_add_u32 s58, s61, 16384
s_mov_b64 exec, 0xffff
buffer_store_dwordx2 v[232:233], v238, s[24:27], s58 offen sc1
s_mov_b64 exec, -1
L_if41:
v_mfma_f32_16x16x32_bf16 v[136:139], v[52:55], v[160:163], v[136:139]
v_add_u32 v3, 0x10000, v3
ds_read_b64_tr_b16 v[36:37], v3 offset:16384
ds_read_b64_tr_b16 v[38:39], v3 offset:20480
v_lshlrev_b32 v244, 16, v28
v_and_b32 v245, 0xffff0000, v28
v_mfma_f32_16x16x32_bf16 v[140:143], v[52:55], v[164:167], v[140:143]
ds_read_b64_tr_b16 v[40:41], v2 offset:24576
ds_read_b64_tr_b16 v[42:43], v2 offset:28672
s_or_b32 s58, s45, s43
s_cmp_eq_u32 s58, 0
s_cselect_b32 s77, -1, 0
v_lshlrev_b32 v246, 16, v29
v_and_b32 v247, 0xffff0000, v29
v_mfma_f32_16x16x32_bf16 v[128:131], v[56:59], v[168:171], v[128:131]
ds_read_b64_tr_b16 v[44:45], v3 offset:24576
ds_read_b64_tr_b16 v[46:47], v3 offset:28672
v_lshlrev_b32 v248, 16, v30
v_and_b32 v249, 0xffff0000, v30
v_mfma_f32_16x16x32_bf16 v[132:135], v[56:59], v[172:175], v[132:135]
s_add_u32 m0, s49, 0x10000
s_mul_i32 s46, s71, 3584
s_add_u32 s46, s46, s53
buffer_load_dwordx4 v5, s[12:15], s46 offen offset:0 lds
s_mov_b32 s98, 0xf0000
s_mov_b32 s99, 0xfff00ff
v_lshlrev_b32 v250, 16, v31
v_and_b32 v251, 0xffff0000, v31
v_mfma_f32_16x16x32_bf16 v[136:139], v[60:63], v[168:171], v[136:139]
v_add_f32 v24, v244, v245
v_add_f32 v25, v246, v247
v_mfma_f32_16x16x32_bf16 v[140:143], v[60:63], v[172:175], v[140:143]
s_setprio 3
s_waitcnt lgkmcnt(0)
s_add_u32 s46, s46, 0x1bc00
buffer_load_dwordx4 v5, s[12:15], s46 offen offset:1024 lds
s_and_b32 s64, s98, s77
s_and_b32 s65, s99, s77
s_or_b32 s64, s64, 0xf00fff00
s_or_b32 s65, s65, 0xff000ff
v_add_f32 v26, v248, v249
v_add_f32 v27, v250, v251
v_mfma_f32_16x16x32_bf16 v[96:99], v[32:35], v[176:179], v[96:99]
v_add_u32 v19, 0x10000, v19
ds_read_b128 v[184:187], v19 offset:49152
ds_read_b128 v[188:191], v19 offset:51200
v_add_f32 v24, v24, v25
v_add_f32 v26, v26, v27
v_mfma_f32_16x16x32_bf16 v[100:103], v[32:35], v[180:183], v[100:103]
ds_read_b64_tr_b16 v[48:49], v2 offset:17408
ds_read_b64_tr_b16 v[50:51], v2 offset:21504
s_mov_b32 s40, 0x1f0001
s_mov_b32 s41, 0x1fff01ff
v_add_f32 v24, v24, v26
s_nop 1
v_add_f32_dpp v24, v24, v24 row_shr:1 row_mask:0xf bank_mask:0xf bound_ctrl:0
v_mfma_f32_16x16x32_bf16 v[104:107], v[36:39], v[176:179], v[104:107]
ds_read_b64_tr_b16 v[52:53], v3 offset:17408
ds_read_b64_tr_b16 v[54:55], v3 offset:21504
s_add_u32 m0, s50, 0x14000
s_lshl1_add_u32 s46, s72, s51
buffer_load_dwordx4 v20, s[4:7], s46 offen offset:0 lds
v_add_f32_dpp v24, v24, v24 row_shr:2 row_mask:0xf bank_mask:0xf bound_ctrl:0
s_nop 1
v_add_f32_dpp v24, v24, v24 row_shr:4 row_mask:0xf bank_mask:0xf bound_ctrl:0
v_mfma_f32_16x16x32_bf16 v[108:111], v[36:39], v[180:183], v[108:111]
ds_read_b64_tr_b16 v[56:57], v2 offset:25600
ds_read_b64_tr_b16 v[58:59], v2 offset:29696
s_and_b32 s66, s40, s77
s_and_b32 s67, s41, s77
s_or_b32 s66, s66, 0xe01ffe01
s_or_b32 s67, s67, 0x1fe001fe
v_add_f32_dpp v24, v24, v24 row_shr:8 row_mask:0xf bank_mask:0xf bound_ctrl:0
v_mfma_f32_16x16x32_bf16 v[112:115], v[40:43], v[176:179], v[112:115]
ds_read_b64_tr_b16 v[60:61], v3 offset:25600
ds_read_b64_tr_b16 v[62:63], v3 offset:29696
v_add_f32_dpp v24, v24, v24 row_bcast:15 row_mask:0xa bank_mask:0xf
s_nop 1
v_add_f32_dpp v24, v24, v24 row_bcast:31 row_mask:0xc bank_mask:0xf
v_mfma_f32_16x16x32_bf16 v[116:119], v[40:43], v[180:183], v[116:119]
buffer_load_dwordx4 v21, s[4:7], s46 offen offset:1024 lds
s_mov_b32 s78, 0x3f0003
s_mov_b32 s79, 0x3fff03ff
v_mul_f32 v24, 0x3b000000, v24
s_nop 0
v_readlane_b32 s84, v24, 63
v_mfma_f32_16x16x32_bf16 v[120:123], v[44:47], v[176:179], v[120:123]
s_nop 0
v_subrev_f32 v244, s84, v244
v_subrev_f32 v245, s84, v245
v_mfma_f32_16x16x32_bf16 v[124:127], v[44:47], v[180:183], v[124:127]
s_setprio 2
s_waitcnt lgkmcnt(0)
s_and_b32 s32, s78, s77
s_and_b32 s33, s79, s77
s_or_b32 s32, s32, 0xc03ffc03
s_or_b32 s33, s33, 0x3fc003fc
v_subrev_f32 v246, s84, v246
v_subrev_f32 v247, s84, v247
v_mfma_f32_16x16x32_bf16 v[96:99], v[48:51], v[184:187], v[96:99]
v_add_u32 v2, 0xfffe0000, v2
ds_read_b64_tr_b16 v[32:33], v2 offset:0
ds_read_b64_tr_b16 v[34:35], v2 offset:4096
s_add_u32 m0, s49, 0x18000
s_mul_i32 s46, s72, 3072
s_add_u32 s46, s46, s52
buffer_load_dwordx4 v4, s[8:11], s46 offen offset:0 lds
v_subrev_f32 v248, s84, v248
v_subrev_f32 v249, s84, v249
v_mfma_f32_16x16x32_bf16 v[100:103], v[48:51], v[188:191], v[100:103]
v_add_u32 v3, 0xfffe0000, v3
ds_read_b64_tr_b16 v[36:37], v3 offset:0
ds_read_b64_tr_b16 v[38:39], v3 offset:4096
s_mov_b32 s80, 0x7f0007
s_mov_b32 s81, 0x7fff07ff
v_subrev_f32 v250, s84, v250
v_subrev_f32 v251, s84, v251
v_mfma_f32_16x16x32_bf16 v[104:107], v[52:55], v[184:187], v[104:107]
ds_read_b64_tr_b16 v[40:41], v2 offset:8192
ds_read_b64_tr_b16 v[42:43], v2 offset:12288
s_add_u32 s46, s46, 0x17c00
buffer_load_dwordx4 v4, s[8:11], s46 offen offset:1024 lds
v_mul_f32 v26, v244, v244
v_mul_f32 v27, v245, v245
v_mfma_f32_16x16x32_bf16 v[108:111], v[52:55], v[188:191], v[108:111]
ds_read_b64_tr_b16 v[44:45], v3 offset:8192
ds_read_b64_tr_b16 v[46:47], v3 offset:12288
s_and_b32 s34, s80, s77
s_and_b32 s35, s81, s77
s_or_b32 s34, s34, 0x807ff807
s_or_b32 s35, s35, 0x7f8007f8
v_fmac_f32 v26, v246, v246
v_fmac_f32 v27, v247, v247
v_mfma_f32_16x16x32_bf16 v[112:115], v[56:59], v[184:187], v[112:115]
v_fmac_f32 v26, v248, v248
v_fmac_f32 v27, v249, v249
v_mfma_f32_16x16x32_bf16 v[116:119], v[56:59], v[188:191], v[116:119]
s_mov_b32 m0, 0x20f00
s_lshl3_add_u32 s57, s2, s42
s_lshl_b32 s57, s57, 10
buffer_load_dword v1, s[16:19], s57 offen lds
v_fmac_f32 v26, v250, v250
v_mfma_f32_16x16x32_bf16 v[120:123], v[60:63], v[184:187], v[120:123]
v_fmac_f32 v27, v251, v251
v_add_f32 v26, v26, v27
v_mfma_f32_16x16x32_bf16 v[124:127], v[60:63], v[188:191], v[124:127]
s_setprio 1
s_waitcnt lgkmcnt(0)
v_add_f32_dpp v26, v26, v26 row_shr:1 row_mask:0xf bank_mask:0xf bound_ctrl:0
s_nop 1
v_add_f32_dpp v26, v26, v26 row_shr:2 row_mask:0xf bank_mask:0xf bound_ctrl:0
v_mfma_f32_16x16x32_bf16 v[64:67], v[32:35], v[176:179], v[64:67]
ds_read_b64_tr_b16 v[48:49], v2 offset:1024
ds_read_b64_tr_b16 v[50:51], v2 offset:5120
s_cmp_lt_u32 s2, 64
s_cbranch_scc0 L_if27
s_mov_b32 m0, 0x20f00
s_lshl3_add_u32 s57, s2, s42
s_lshl_b32 s57, s57, 10
buffer_load_dword v1, s[20:23], s57 offen lds
L_if27:
v_add_f32_dpp v26, v26, v26 row_shr:4 row_mask:0xf bank_mask:0xf bound_ctrl:0
s_nop 1
v_add_f32_dpp v26, v26, v26 row_shr:8 row_mask:0xf bank_mask:0xf bound_ctrl:0
v_mfma_f32_16x16x32_bf16 v[68:71], v[32:35], v[180:183], v[68:71]
ds_read_b64_tr_b16 v[52:53], v3 offset:1024
ds_read_b64_tr_b16 v[54:55], v3 offset:5120
v_add_f32_dpp v26, v26, v26 row_bcast:15 row_mask:0xa bank_mask:0xf
s_nop 1
v_add_f32_dpp v26, v26, v26 row_bcast:31 row_mask:0xc bank_mask:0xf
v_mfma_f32_16x16x32_bf16 v[72:75], v[36:39], v[176:179], v[72:75]
ds_read_b64_tr_b16 v[56:57], v2 offset:9216
ds_read_b64_tr_b16 v[58:59], v2 offset:13312
v_mul_f32 v26, 0x3b000000, v26
v_cvt_pk_bf16_f32 v26, v26, v26
v_mfma_f32_16x16x32_bf16 v[76:79], v[36:39], v[180:183], v[76:79]
ds_read_b64_tr_b16 v[60:61], v3 offset:9216
ds_read_b64_tr_b16 v[62:63], v3 offset:13312
v_lshlrev_b32 v26, 16, v26
v_cvt_pk_bf16_f32 v24, v24, v24
v_mfma_f32_16x16x32_bf16 v[80:83], v[40:43], v[176:179], v[80:83]
v_lshlrev_b32 v24, 16, v24
v_add_f32 v26, 0x3727c5ac, v26
v_mfma_f32_16x16x32_bf16 v[84:87], v[40:43], v[180:183], v[84:87]
v_cvt_pk_bf16_f32 v26, v26, v26
v_lshlrev_b32 v26, 16, v26
v_mfma_f32_16x16x32_bf16 v[88:91], v[44:47], v[176:179], v[88:91]
v_sqrt_f32 v26, v26
s_nop 0
v_cvt_pk_bf16_f32 v26, v26, v26
v_mfma_f32_16x16x32_bf16 v[92:95], v[44:47], v[180:183], v[92:95]
s_setprio 0
s_waitcnt lgkmcnt(0)
v_lshlrev_b32 v26, 16, v26
v_mfma_f32_16x16x32_bf16 v[64:67], v[48:51], v[184:187], v[64:67]
ds_read_b64_tr_b16 v[32:33], v2 offset:16384
ds_read_b64_tr_b16 v[34:35], v2 offset:20480
v_mov_b32 v25, v8
v_mov_b32 v27, v8
v_mfma_f32_16x16x32_bf16 v[68:71], v[48:51], v[188:191], v[68:71]
ds_read_b64_tr_b16 v[36:37], v3 offset:16384
ds_read_b64_tr_b16 v[38:39], v3 offset:20480
s_lshl_b32 s58, s88, 4
s_add_u32 s58, s58, 0xb00000
s_mov_b32 exec_lo, 0
s_mov_b32 exec_hi, 0x80000000
buffer_store_dwordx4 v[24:27], v22, s[24:27], s58 offen sc1
s_mov_b64 exec, -1
v_mfma_f32_16x16x32_bf16 v[72:75], v[52:55], v[184:187], v[72:75]
ds_read_b64_tr_b16 v[40:41], v2 offset:17408
ds_read_b64_tr_b16 v[42:43], v2 offset:21504
v_mfma_f32_16x16x32_bf16 v[76:79], v[52:55], v[188:191], v[76:79]
ds_read_b64_tr_b16 v[44:45], v3 offset:17408
ds_read_b64_tr_b16 v[46:47], v3 offset:21504
v_mfma_f32_16x16x32_bf16 v[80:83], v[56:59], v[184:187], v[80:83]
v_mfma_f32_16x16x32_bf16 v[84:87], v[56:59], v[188:191], v[84:87]
v_mfma_f32_16x16x32_bf16 v[88:91], v[60:63], v[184:187], v[88:91]
v_mfma_f32_16x16x32_bf16 v[92:95], v[60:63], v[188:191], v[92:95]
s_waitcnt vmcnt(6) lgkmcnt(0)
s_barrier
s_setprio 3
v_mfma_f32_16x16x32_bf16 v[128:131], v[32:35], v[176:179], v[128:131]
v_add_u32 v18, 0xffff0000, v18
ds_read_b128 v[192:195], v18 offset:32768
ds_read_b128 v[196:199], v18 offset:34816
s_add_u32 m0, s50, 0x0
s_lshl1_add_u32 s46, s73, s51
buffer_load_dwordx4 v20, s[4:7], s46 offen offset:0 lds
buffer_load_dwordx4 v21, s[4:7], s46 offen offset:1024 lds
v_mfma_f32_16x16x32_bf16 v[132:135], v[32:35], v[180:183], v[132:135]
ds_read_b64_tr_b16 v[48:49], v2 offset:49152
ds_read_b64_tr_b16 v[50:51], v2 offset:53248
s_add_u32 m0, s49, 0x1c000
s_mul_i32 s46, s73, 3072
s_add_u32 s46, s46, s52
buffer_load_dwordx4 v4, s[8:11], s46 offen offset:0 lds
v_mfma_f32_16x16x32_bf16 v[136:139], v[36:39], v[176:179], v[136:139]
ds_read_b64_tr_b16 v[52:53], v3 offset:49152
ds_read_b64_tr_b16 v[54:55], v3 offset:53248
v_mfma_f32_16x16x32_bf16 v[140:143], v[36:39], v[180:183], v[140:143]
ds_read_b64_tr_b16 v[56:57], v2 offset:57344
ds_read_b64_tr_b16 v[58:59], v2 offset:61440
v_mfma_f32_16x16x32_bf16 v[128:131], v[40:43], v[184:187], v[128:131]
ds_read_b64_tr_b16 v[60:61], v3 offset:57344
ds_read_b64_tr_b16 v[62:63], v3 offset:61440
s_add_u32 s46, s46, 0x17c00
buffer_load_dwordx4 v4, s[8:11], s46 offen offset:1024 lds
v_mfma_f32_16x16x32_bf16 v[132:135], v[40:43], v[188:191], v[132:135]
v_mfma_f32_16x16x32_bf16 v[136:139], v[44:47], v[184:187], v[136:139]
v_mfma_f32_16x16x32_bf16 v[140:143], v[44:47], v[188:191], v[140:143]
s_setprio 3
s_waitcnt lgkmcnt(0)
v_mfma_f32_16x16x32_bf16 v[96:99], v[48:51], v[192:195], v[96:99]
v_add_u32 v19, 0xffff0000, v19
ds_read_b128 v[200:203], v19 offset:32768
ds_read_b128 v[204:207], v19 offset:34816
s_add_u32 m0, s50, 0x24000
s_lshl1_add_u32 s46, s74, s51
buffer_load_dwordx4 v20, s[4:7], s46 offen offset:0 lds
v_mfma_f32_16x16x32_bf16 v[100:103], v[48:51], v[196:199], v[100:103]
ds_read_b64_tr_b16 v[32:33], v2 offset:50176
ds_read_b64_tr_b16 v[34:35], v2 offset:54272
v_mfma_f32_16x16x32_bf16 v[104:107], v[52:55], v[192:195], v[104:107]
ds_read_b64_tr_b16 v[36:37], v3 offset:50176
ds_read_b64_tr_b16 v[38:39], v3 offset:54272
v_mfma_f32_16x16x32_bf16 v[108:111], v[52:55], v[196:199], v[108:111]
ds_read_b64_tr_b16 v[40:41], v2 offset:58368
ds_read_b64_tr_b16 v[42:43], v2 offset:62464
buffer_load_dwordx4 v21, s[4:7], s46 offen offset:1024 lds
v_mfma_f32_16x16x32_bf16 v[112:115], v[56:59], v[192:195], v[112:115]
ds_read_b64_tr_b16 v[44:45], v3 offset:58368
ds_read_b64_tr_b16 v[46:47], v3 offset:62464
v_mfma_f32_16x16x32_bf16 v[116:119], v[56:59], v[196:199], v[116:119]
v_mfma_f32_16x16x32_bf16 v[120:123], v[60:63], v[192:195], v[120:123]
v_mfma_f32_16x16x32_bf16 v[124:127], v[60:63], v[196:199], v[124:127]
s_setprio 2
s_waitcnt lgkmcnt(0)
v_mfma_f32_16x16x32_bf16 v[96:99], v[32:35], v[200:203], v[96:99]
v_add_u32 v2, 0x10000, v2
ds_read_b64_tr_b16 v[48:49], v2 offset:0
ds_read_b64_tr_b16 v[50:51], v2 offset:4096
v_mfma_f32_16x16x32_bf16 v[100:103], v[32:35], v[204:207], v[100:103]
v_add_u32 v3, 0x10000, v3
ds_read_b64_tr_b16 v[52:53], v3 offset:0
ds_read_b64_tr_b16 v[54:55], v3 offset:4096
v_mfma_f32_16x16x32_bf16 v[104:107], v[36:39], v[200:203], v[104:107]
ds_read_b64_tr_b16 v[56:57], v2 offset:8192
ds_read_b64_tr_b16 v[58:59], v2 offset:12288
v_mfma_f32_16x16x32_bf16 v[108:111], v[36:39], v[204:207], v[108:111]
ds_read_b64_tr_b16 v[60:61], v3 offset:8192
ds_read_b64_tr_b16 v[62:63], v3 offset:12288
v_mfma_f32_16x16x32_bf16 v[112:115], v[40:43], v[200:203], v[112:115]
v_mfma_f32_16x16x32_bf16 v[116:119], v[40:43], v[204:207], v[116:119]
v_mfma_f32_16x16x32_bf16 v[120:123], v[44:47], v[200:203], v[120:123]
v_mfma_f32_16x16x32_bf16 v[124:127], v[44:47], v[204:207], v[124:127]
s_setprio 1
s_waitcnt lgkmcnt(0)
v_mfma_f32_16x16x32_bf16 v[64:67], v[48:51], v[192:195], v[64:67]
ds_read_b64_tr_b16 v[32:33], v2 offset:1024
ds_read_b64_tr_b16 v[34:35], v2 offset:5120
v_mfma_f32_16x16x32_bf16 v[68:71], v[48:51], v[196:199], v[68:71]
ds_read_b64_tr_b16 v[36:37], v3 offset:1024
ds_read_b64_tr_b16 v[38:39], v3 offset:5120
v_mfma_f32_16x16x32_bf16 v[72:75], v[52:55], v[192:195], v[72:75]
ds_read_b64_tr_b16 v[40:41], v2 offset:9216
ds_read_b64_tr_b16 v[42:43], v2 offset:13312
v_mfma_f32_16x16x32_bf16 v[76:79], v[52:55], v[196:199], v[76:79]
ds_read_b64_tr_b16 v[44:45], v3 offset:9216
ds_read_b64_tr_b16 v[46:47], v3 offset:13312
v_mfma_f32_16x16x32_bf16 v[80:83], v[56:59], v[192:195], v[80:83]
v_mfma_f32_16x16x32_bf16 v[84:87], v[56:59], v[196:199], v[84:87]
v_mfma_f32_16x16x32_bf16 v[88:91], v[60:63], v[192:195], v[88:91]
s_cmp_eq_u32 s43, 0
s_cbranch_scc0 L_if26
s_add_u32 s58, s62, 16384
buffer_load_dwordx4 v[224:227], v241, s[24:27], s58 offen sc1
s_add_u32 s58, s58, 4096
buffer_load_dwordx4 v[232:235], v241, s[24:27], s58 offen sc1
L_if26:
s_add_u32 s58, s83, s62
buffer_load_dwordx4 v[208:211], v241, s[24:27], s58 offen sc1
s_add_u32 s58, s58, 4096
buffer_load_dwordx4 v[216:219], v241, s[24:27], s58 offen sc1
v_mfma_f32_16x16x32_bf16 v[92:95], v[60:63], v[196:199], v[92:95]
s_setprio 0
s_waitcnt lgkmcnt(0)
v_mfma_f32_16x16x32_bf16 v[64:67], v[32:35], v[200:203], v[64:67]
v_add_u32 v2, 0xffff0000, v2
ds_read_b64_tr_b16 v[48:49], v2 offset:24576
ds_read_b64_tr_b16 v[50:51], v2 offset:28672
v_mfma_f32_16x16x32_bf16 v[68:71], v[32:35], v[204:207], v[68:71]
v_add_u32 v3, 0xffff0000, v3
ds_read_b64_tr_b16 v[52:53], v3 offset:24576
ds_read_b64_tr_b16 v[54:55], v3 offset:28672
v_mfma_f32_16x16x32_bf16 v[72:75], v[36:39], v[200:203], v[72:75]
ds_read_b64_tr_b16 v[56:57], v2 offset:25600
ds_read_b64_tr_b16 v[58:59], v2 offset:29696
v_mfma_f32_16x16x32_bf16 v[76:79], v[36:39], v[204:207], v[76:79]
ds_read_b64_tr_b16 v[60:61], v3 offset:25600
ds_read_b64_tr_b16 v[62:63], v3 offset:29696
v_mfma_f32_16x16x32_bf16 v[80:83], v[40:43], v[200:203], v[80:83]
v_mfma_f32_16x16x32_bf16 v[84:87], v[40:43], v[204:207], v[84:87]
v_mfma_f32_16x16x32_bf16 v[88:91], v[44:47], v[200:203], v[88:91]
v_mfma_f32_16x16x32_bf16 v[92:95], v[44:47], v[204:207], v[92:95]
s_waitcnt vmcnt(4) lgkmcnt(0)
s_barrier
s_setprio 3
v_mfma_f32_16x16x32_bf16 v[128:131], v[48:51], v[192:195], v[128:131]
v_add_u32 v18, 0x10000, v18
ds_read_b128 v[144:147], v18 offset:16384
ds_read_b128 v[148:151], v18 offset:18432
s_add_u32 m0, s49, 0x4000
s_mul_i32 s46, s74, 3072
s_add_u32 s46, s46, s52
buffer_load_dwordx4 v4, s[8:11], s46 offen offset:0 lds
s_add_u32 s46, s46, 0x17c00
buffer_load_dwordx4 v4, s[8:11], s46 offen offset:1024 lds
v_mfma_f32_16x16x32_bf16 v[132:135], v[48:51], v[196:199], v[132:135]
v_add_u32 v2, 0x10000, v2
ds_read_b64_tr_b16 v[32:33], v2 offset:32768
ds_read_b64_tr_b16 v[34:35], v2 offset:36864
s_add_u32 m0, s50, 0x8000
s_lshl1_add_u32 s46, s75, s51
buffer_load_dwordx4 v20, s[4:7], s46 offen offset:0 lds
v_mfma_f32_16x16x32_bf16 v[136:139], v[52:55], v[192:195], v[136:139]
v_add_u32 v3, 0x10000, v3
ds_read_b64_tr_b16 v[36:37], v3 offset:32768
ds_read_b64_tr_b16 v[38:39], v3 offset:36864
v_mfma_f32_16x16x32_bf16 v[140:143], v[52:55], v[196:199], v[140:143]
ds_read_b64_tr_b16 v[40:41], v2 offset:40960
ds_read_b64_tr_b16 v[42:43], v2 offset:45056
v_mfma_f32_16x16x32_bf16 v[128:131], v[56:59], v[200:203], v[128:131]
ds_read_b64_tr_b16 v[44:45], v3 offset:40960
ds_read_b64_tr_b16 v[46:47], v3 offset:45056
buffer_load_dwordx4 v21, s[4:7], s46 offen offset:1024 lds
v_mfma_f32_16x16x32_bf16 v[132:135], v[56:59], v[204:207], v[132:135]
s_lshl_b32 s58, s44, 6
v_xor_b32 v20, s58, v1
v_and_b32 v20, 0x60, v20
v_mfma_f32_16x16x32_bf16 v[136:139], v[60:63], v[200:203], v[136:139]
s_add_u32 m0, s49, 0xc000
s_mul_i32 s46, s75, 3072
s_add_u32 s46, s46, s52
buffer_load_dwordx4 v4, s[8:11], s46 offen offset:0 lds
v_lshrrev_b32 v21, 8, v1
v_bfe_u32 v242, v1, 4, 1
v_xor_b32 v21, v21, v242
v_bfe_u32 v242, v1, 7, 1
v_lshlrev_b32 v242, 1, v242
v_xor_b32 v21, v21, v242
v_lshl_add_u32 v20, v21, 3, v20
v_mfma_f32_16x16x32_bf16 v[140:143], v[60:63], v[204:207], v[140:143]
s_setprio 2
s_waitcnt lgkmcnt(0)
v_mfma_f32_16x16x32_bf16 v[96:99], v[32:35], v[144:147], v[96:99]
v_add_u32 v19, 0x10000, v19
ds_read_b128 v[152:155], v19 offset:16384
ds_read_b128 v[156:159], v19 offset:18432
v_and_b32 v21, 0x80, v1
v_lshl_add_u32 v20, v21, 4, v20
v_mfma_f32_16x16x32_bf16 v[100:103], v[32:35], v[148:151], v[100:103]
ds_read_b64_tr_b16 v[48:49], v2 offset:33792
ds_read_b64_tr_b16 v[50:51], v2 offset:37888
s_add_u32 s46, s46, 0x17c00
buffer_load_dwordx4 v4, s[8:11], s46 offen offset:1024 lds
v_mfma_f32_16x16x32_bf16 v[104:107], v[36:39], v[144:147], v[104:107]
ds_read_b64_tr_b16 v[52:53], v3 offset:33792
ds_read_b64_tr_b16 v[54:55], v3 offset:37888
v_and_b32 v21, 0x70, v1
v_lshl_add_u32 v20, v21, 3, v20
v_mfma_f32_16x16x32_bf16 v[108:111], v[36:39], v[148:151], v[108:111]
ds_read_b64_tr_b16 v[56:57], v2 offset:41984
ds_read_b64_tr_b16 v[58:59], v2 offset:46080
s_lshl_b32 s58, s43, 12
s_add_u32 s58, s58, 0x23000
v_add_u32 v20, s58, v20
v_mfma_f32_16x16x32_bf16 v[112:115], v[40:43], v[144:147], v[112:115]
ds_read_b64_tr_b16 v[60:61], v3 offset:41984
ds_read_b64_tr_b16 v[62:63], v3 offset:46080
v_mfma_f32_16x16x32_bf16 v[116:119], v[40:43], v[148:151], v[116:119]
s_add_u32 m0, s49, 0x10000
s_mul_i32 s46, s72, 3584
s_add_u32 s46, s46, s53
buffer_load_dwordx4 v5, s[12:15], s46 offen offset:0 lds
s_lshr_b32 s58, s50, 1
s_add_u32 s58, s58, 0x21000
v_add_u32 v21, s58, v21
v_lshrrev_b32 v242, 8, v1
v_lshl_add_u32 v21, v242, 7, v21
v_mfma_f32_16x16x32_bf16 v[120:123], v[44:47], v[144:147], v[120:123]
v_mfma_f32_16x16x32_bf16 v[124:127], v[44:47], v[148:151], v[124:127]
s_setprio 1
s_waitcnt lgkmcnt(0)
v_mfma_f32_16x16x32_bf16 v[96:99], v[48:51], v[152:155], v[96:99]
v_add_u32 v18, 0xffff0000, v18
ds_read_b128 v[160:163], v18 offset:0
ds_read_b128 v[164:167], v18 offset:2048
s_add_u32 s46, s46, 0x1bc00
buffer_load_dwordx4 v5, s[12:15], s46 offen offset:1024 lds
v_mfma_f32_16x16x32_bf16 v[100:103], v[48:51], v[156:159], v[100:103]
ds_read_b64_tr_b16 v[32:33], v2 offset:49152
ds_read_b64_tr_b16 v[34:35], v2 offset:53248
v_mfma_f32_16x16x32_bf16 v[104:107], v[52:55], v[152:155], v[104:107]
ds_read_b64_tr_b16 v[36:37], v3 offset:49152
ds_read_b64_tr_b16 v[38:39], v3 offset:53248
v_mfma_f32_16x16x32_bf16 v[108:111], v[52:55], v[156:159], v[108:111]
ds_read_b64_tr_b16 v[40:41], v2 offset:57344
ds_read_b64_tr_b16 v[42:43], v2 offset:61440
v_mfma_f32_16x16x32_bf16 v[112:115], v[56:59], v[152:155], v[112:115]
ds_read_b64_tr_b16 v[44:45], v3 offset:57344
ds_read_b64_tr_b16 v[46:47], v3 offset:61440
buffer_load_dwordx4 v[28:31], v23, s[24:27], s63 offen sc1
s_waitcnt vmcnt(10)
v_min3_u32 v212, v209, v211, v8
v_max3_u32 v213, v209, v211, v8
s_waitcnt vmcnt(9)
v_min3_u32 v212, v217, v219, v212
v_max3_u32 v213, v217, v219, v213
v_cmp_ne_u32 vcc, v212, v213
s_cbranch_vccnz L_slow42
L_back43:
v_add_f32 v208, v208, v216
v_mfma_f32_16x16x32_bf16 v[116:119], v[56:59], v[156:159], v[116:119]
v_add_f32 v210, v210, v218
v_mfma_f32_16x16x32_bf16 v[120:123], v[60:63], v[152:155], v[120:123]
s_nop 0
v_permlane32_swap_b32 v208, v210
v_mfma_f32_16x16x32_bf16 v[124:127], v[60:63], v[156:159], v[124:127]
s_setprio 0
s_waitcnt lgkmcnt(0)
v_add_f32 v208, v208, v210
v_mfma_f32_16x16x32_bf16 v[96:99], v[32:35], v[160:163], v[96:99]
v_add_u32 v19, 0xffff0000, v19
ds_read_b128 v[168:171], v19 offset:0
ds_read_b128 v[172:175], v19 offset:2048
v_mov_b32 v210, v208
v_mfma_f32_16x16x32_bf16 v[100:103], v[32:35], v[164:167], v[100:103]
ds_read_b64_tr_b16 v[48:49], v2 offset:50176
ds_read_b64_tr_b16 v[50:51], v2 offset:54272
v_permlane16_swap_b32 v208, v210
v_mfma_f32_16x16x32_bf16 v[104:107], v[36:39], v[160:163], v[104:107]
ds_read_b64_tr_b16 v[52:53], v3 offset:50176
ds_read_b64_tr_b16 v[54:55], v3 offset:54272
v_add_f32 v208, v208, v210
v_mfma_f32_16x16x32_bf16 v[108:111], v[36:39], v[164:167], v[108:111]
ds_read_b64_tr_b16 v[56:57], v2 offset:58368
ds_read_b64_tr_b16 v[58:59], v2 offset:62464
ds_write_b32 v240, v208
v_mfma_f32_16x16x32_bf16 v[112:115], v[40:43], v[160:163], v[112:115]
ds_read_b64_tr_b16 v[60:61], v3 offset:58368
ds_read_b64_tr_b16 v[62:63], v3 offset:62464
s_cmp_eq_u32 s43, 0
s_cbranch_scc0 L_if48
v_min3_u32 v228, v225, v227, v8
v_max3_u32 v229, v225, v227, v8
v_min3_u32 v228, v233, v235, v228
v_max3_u32 v229, v233, v235, v229
v_cmp_ne_u32 vcc, v228, v229
s_cbranch_vccnz L_slow45
L_back46:
v_add_f32 v224, v224, v232
v_add_f32 v226, v226, v234
s_nop 1
v_permlane32_swap_b32 v224, v226
v_add_f32 v224, v224, v226
v_mov_b32 v226, v224
s_nop 1
v_permlane16_swap_b32 v224, v226
v_add_f32 v224, v224, v226
ds_write_b32 v240, v224 offset:512
L_if48:
v_mfma_f32_16x16x32_bf16 v[116:119], v[40:43], v[164:167], v[116:119]
v_mfma_f32_16x16x32_bf16 v[120:123], v[44:47], v[160:163], v[120:123]
v_mfma_f32_16x16x32_bf16 v[124:127], v[44:47], v[164:167], v[124:127]
s_waitcnt vmcnt(3) lgkmcnt(0)
s_barrier
s_setprio 3
v_mfma_f32_16x16x32_bf16 v[96:99], v[48:51], v[168:171], v[96:99]
v_add_u32 v18, 0x20000, v18
ds_read_b128 v[176:179], v18 offset:16384
ds_read_b128 v[180:183], v18 offset:18432
s_add_u32 m0, s49, 0x0
s_mul_i32 s46, s73, 3584
s_add_u32 s46, s46, s53
buffer_load_dwordx4 v5, s[12:15], s46 offen offset:0 lds
s_add_u32 s46, s46, 0x1bc00
buffer_load_dwordx4 v5, s[12:15], s46 offen offset:1024 lds
v_mfma_f32_16x16x32_bf16 v[100:103], v[48:51], v[172:175], v[100:103]
v_add_u32 v2, 0xffff0000, v2
ds_read_b64_tr_b16 v[32:33], v2 offset:16384
ds_read_b64_tr_b16 v[34:35], v2 offset:20480
s_add_u32 m0, s49, 0x14000
s_mul_i32 s46, s74, 3584
s_add_u32 s46, s46, s53
buffer_load_dwordx4 v5, s[12:15], s46 offen offset:0 lds
v_mfma_f32_16x16x32_bf16 v[104:107], v[52:55], v[168:171], v[104:107]
v_add_u32 v3, 0xffff0000, v3
ds_read_b64_tr_b16 v[36:37], v3 offset:16384
ds_read_b64_tr_b16 v[38:39], v3 offset:20480
v_mfma_f32_16x16x32_bf16 v[108:111], v[52:55], v[172:175], v[108:111]
ds_read_b64_tr_b16 v[40:41], v2 offset:24576
ds_read_b64_tr_b16 v[42:43], v2 offset:28672
v_mfma_f32_16x16x32_bf16 v[112:115], v[56:59], v[168:171], v[112:115]
ds_read_b64_tr_b16 v[44:45], v3 offset:24576
ds_read_b64_tr_b16 v[46:47], v3 offset:28672
s_add_u32 s46, s46, 0x1bc00
buffer_load_dwordx4 v5, s[12:15], s46 offen offset:1024 lds
v_mfma_f32_16x16x32_bf16 v[116:119], v[56:59], v[172:175], v[116:119]
v_mfma_f32_16x16x32_bf16 v[120:123], v[60:63], v[168:171], v[120:123]
v_mfma_f32_16x16x32_bf16 v[124:127], v[60:63], v[172:175], v[124:127]
s_setprio 2
s_waitcnt lgkmcnt(0)
v_mfma_f32_16x16x32_bf16 v[96:99], v[32:35], v[176:179], v[96:99]
v_add_u32 v19, 0x20000, v19
ds_read_b128 v[184:187], v19 offset:16384
ds_read_b128 v[188:191], v19 offset:18432
s_add_u32 m0, s49, 0x18000
s_mul_i32 s46, s75, 3584
s_add_u32 s46, s46, s53
buffer_load_dwordx4 v5, s[12:15], s46 offen offset:0 lds
v_mfma_f32_16x16x32_bf16 v[100:103], v[32:35], v[180:183], v[100:103]
ds_read_b64_tr_b16 v[48:49], v2 offset:17408
ds_read_b64_tr_b16 v[50:51], v2 offset:21504
v_mfma_f32_16x16x32_bf16 v[104:107], v[36:39], v[176:179], v[104:107]
ds_read_b64_tr_b16 v[52:53], v3 offset:17408
ds_read_b64_tr_b16 v[54:55], v3 offset:21504
v_mfma_f32_16x16x32_bf16 v[108:111], v[36:39], v[180:183], v[108:111]
ds_read_b64_tr_b16 v[56:57], v2 offset:25600
ds_read_b64_tr_b16 v[58:59], v2 offset:29696
s_add_u32 s46, s46, 0x1bc00
buffer_load_dwordx4 v5, s[12:15], s46 offen offset:1024 lds
v_mfma_f32_16x16x32_bf16 v[112:115], v[40:43], v[176:179], v[112:115]
ds_read_b64_tr_b16 v[60:61], v3 offset:25600
ds_read_b64_tr_b16 v[62:63], v3 offset:29696
v_mfma_f32_16x16x32_bf16 v[116:119], v[40:43], v[180:183], v[116:119]
v_mfma_f32_16x16x32_bf16 v[120:123], v[44:47], v[176:179], v[120:123]
v_mfma_f32_16x16x32_bf16 v[124:127], v[44:47], v[180:183], v[124:127]
s_setprio 1
s_waitcnt lgkmcnt(0)
s_add_u32 m0, s49, 0x1c000
s_cmp_eq_u32 s44, 0
s_cselect_b32 s46, s72, s73
s_mul_i32 s46, s46, 3072
s_add_u32 s46, s46, s54
buffer_load_dwordx4 v4, s[8:11], s46 offen offset:0 lds
v_mfma_f32_16x16x32_bf16 v[96:99], v[48:51], v[184:187], v[96:99]
v_add_u32 v18, 0xfffe0000, v18
ds_read_b128 v[192:195], v18 offset:32768
ds_read_b128 v[196:199], v18 offset:34816
v_mfma_f32_16x16x32_bf16 v[100:103], v[48:51], v[188:191], v[100:103]
ds_read_b64_tr_b16 v[32:33], v2 offset:49152
ds_read_b64_tr_b16 v[34:35], v2 offset:53248
v_mfma_f32_16x16x32_bf16 v[104:107], v[52:55], v[184:187], v[104:107]
ds_read_b64_tr_b16 v[36:37], v3 offset:49152
ds_read_b64_tr_b16 v[38:39], v3 offset:53248
s_add_u32 s46, s46, 0x17c00
buffer_load_dwordx4 v4, s[8:11], s46 offen offset:1024 lds
v_mfma_f32_16x16x32_bf16 v[108:111], v[52:55], v[188:191], v[108:111]
ds_read_b64_tr_b16 v[40:41], v2 offset:57344
ds_read_b64_tr_b16 v[42:43], v2 offset:61440
v_mfma_f32_16x16x32_bf16 v[112:115], v[56:59], v[184:187], v[112:115]
ds_read_b64_tr_b16 v[44:45], v3 offset:57344
ds_read_b64_tr_b16 v[46:47], v3 offset:61440
s_waitcnt vmcnt(8)
v_min3_u32 v22, v29, v31, v8
v_max3_u32 v13, v29, v31, v8
v_cmp_ne_u32 vcc, v22, v13
s_cbranch_vccnz L_slow49
L_back50:
v_mfma_f32_16x16x32_bf16 v[116:119], v[56:59], v[188:191], v[116:119]
v_rcp_f32 v29, v30
v_mfma_f32_16x16x32_bf16 v[120:123], v[60:63], v[184:187], v[120:123]
v_mul_f32 v12, v30, v30
v_mfma_f32_16x16x32_bf16 v[124:127], v[60:63], v[188:191], v[124:127]
s_setprio 0
s_waitcnt lgkmcnt(0)
v_mul_f32 v10, 0xbfb8aa3b, v29
v_mfma_f32_16x16x32_bf16 v[96:99], v[32:35], v[192:195], v[96:99]
v_add_u32 v19, 0xfffe0000, v19
ds_read_b128 v[200:203], v19 offset:32768
ds_read_b128 v[204:207], v19 offset:34816
v_sub_f32 v14, 0, v28
v_mfma_f32_16x16x32_bf16 v[100:103], v[32:35], v[196:199], v[100:103]
ds_read_b64_tr_b16 v[48:49], v2 offset:50176
ds_read_b64_tr_b16 v[50:51], v2 offset:54272
v_mov_b32 v13, v12
v_mfma_f32_16x16x32_bf16 v[104:107], v[36:39], v[192:195], v[104:107]
ds_read_b64_tr_b16 v[52:53], v3 offset:50176
ds_read_b64_tr_b16 v[54:55], v3 offset:54272
v_mov_b32 v11, v10
v_mfma_f32_16x16x32_bf16 v[108:111], v[36:39], v[196:199], v[108:111]
ds_read_b64_tr_b16 v[56:57], v2 offset:58368
ds_read_b64_tr_b16 v[58:59], v2 offset:62464
v_mfma_f32_16x16x32_bf16 v[112:115], v[40:43], v[192:195], v[112:115]
ds_read_b64_tr_b16 v[60:61], v3 offset:58368
ds_read_b64_tr_b16 v[62:63], v3 offset:62464
v_permlane16_swap_b32 v12, v13
v_mfma_f32_16x16x32_bf16 v[116:119], v[40:43], v[196:199], v[116:119]
v_permlane16_swap_b32 v10, v11
v_mfma_f32_16x16x32_bf16 v[120:123], v[44:47], v[192:195], v[120:123]
v_mfma_f32_16x16x32_bf16 v[124:127], v[44:47], v[196:199], v[124:127]
s_waitcnt vmcnt(6) lgkmcnt(0)
s_barrier
s_setprio 3
v_mfma_f32_16x16x32_bf16 v[96:99], v[48:51], v[200:203], v[96:99]
v_add_u32 v2, 0x10000, v2
ds_read_b64_tr_b16 v[32:33], v2 offset:0
ds_read_b64_tr_b16 v[34:35], v2 offset:4096
s_add_u32 m0, s49, 0x4000
s_cmp_eq_u32 s44, 0
s_cselect_b32 s46, s74, s75
s_mul_i32 s46, s46, 3072
s_add_u32 s46, s46, s54
buffer_load_dwordx4 v4, s[8:11], s46 offen offset:0 lds
s_add_u32 s46, s46, 0x17c00
buffer_load_dwordx4 v4, s[8:11], s46 offen offset:1024 lds
ds_read_b32 v24, v6 offset:0
v_mfma_f32_16x16x32_bf16 v[100:103], v[48:51], v[204:207], v[100:103]
v_add_u32 v3, 0x10000, v3
ds_read_b64_tr_b16 v[36:37], v3 offset:0
ds_read_b64_tr_b16 v[38:39], v3 offset:4096
s_add_u32 m0, s49, 0x8000
s_add_u32 s46, s55, 0x20000
buffer_load_dwordx4 v17, s[16:19], s46 offen offset:0 lds
ds_read_b32 v25, v6 offset:128
v_mfma_f32_16x16x32_bf16 v[104:107], v[52:55], v[200:203], v[104:107]
ds_read_b64_tr_b16 v[40:41], v2 offset:8192
ds_read_b64_tr_b16 v[42:43], v2 offset:12288
v_mul_f32 v22, 0xbf317218, v10
v_mfma_f32_16x16x32_bf16 v[108:111], v[52:55], v[204:207], v[108:111]
ds_read_b64_tr_b16 v[44:45], v3 offset:8192
ds_read_b64_tr_b16 v[46:47], v3 offset:12288
v_mul_f32 v23, 0xbf317218, v11
v_mfma_f32_16x16x32_bf16 v[112:115], v[56:59], v[200:203], v[112:115]
s_add_u32 m0, s49, 0x8400
s_add_u32 s46, s55, 0x28000
buffer_load_dwordx4 v17, s[16:19], s46 offen offset:0 lds
v_xor_b32 v7, 32, v20
v_mfma_f32_16x16x32_bf16 v[116:119], v[56:59], v[204:207], v[116:119]
v_mfma_f32_16x16x32_bf16 v[120:123], v[60:63], v[200:203], v[120:123]
v_mfma_f32_16x16x32_bf16 v[124:127], v[60:63], v[204:207], v[124:127]
s_setprio 2
s_waitcnt lgkmcnt(0)
s_add_u32 m0, s49, 0xc000
s_add_u32 s46, s55, 0x30000
buffer_load_dwordx4 v17, s[16:19], s46 offen offset:0 lds
v_mfma_f32_16x16x1_4b_f32 v[96:111], v24, v14, v[96:111]
v_mfma_f32_16x16x1_4b_f32 v[112:127], v25, v14, v[112:127]
s_nop 8
v_mul_f32 v96, v22, v96
v_mul_f32 v97, v22, v97
v_mul_f32 v98, v22, v98
v_mul_f32 v99, v22, v99
v_cvt_pk_bf16_f32 v240, v96, v97
v_cvt_pk_bf16_f32 v241, v98, v99
v_mul_f32 v100, v23, v100
v_mul_f32 v101, v23, v101
v_mul_f32 v102, v23, v102
v_mul_f32 v103, v23, v103
v_cvt_pk_bf16_f32 v242, v100, v101
v_cvt_pk_bf16_f32 v243, v102, v103
v_mul_f32 v104, v22, v104
v_mul_f32 v105, v22, v105
v_mul_f32 v106, v22, v106
v_mul_f32 v107, v22, v107
v_cvt_pk_bf16_f32 v244, v104, v105
v_cvt_pk_bf16_f32 v245, v106, v107
v_mul_f32 v108, v23, v108
v_mul_f32 v109, v23, v109
v_mul_f32 v110, v23, v110
v_mul_f32 v111, v23, v111
v_cvt_pk_bf16_f32 v246, v108, v109
v_cvt_pk_bf16_f32 v247, v110, v111
v_mul_f32 v112, v22, v112
v_mul_f32 v113, v22, v113
v_mul_f32 v114, v22, v114
v_mul_f32 v115, v22, v115
v_cvt_pk_bf16_f32 v112, v112, v113
v_cvt_pk_bf16_f32 v113, v114, v115
v_mul_f32 v116, v23, v116
v_mul_f32 v117, v23, v117
v_mul_f32 v118, v23, v118
v_mul_f32 v119, v23, v119
v_cvt_pk_bf16_f32 v114, v116, v117
v_cvt_pk_bf16_f32 v115, v118, v119
v_mul_f32 v120, v22, v120
v_mul_f32 v121, v22, v121
v_mul_f32 v122, v22, v122
v_mul_f32 v123, v22, v123
v_cvt_pk_bf16_f32 v116, v120, v121
v_cvt_pk_bf16_f32 v117, v122, v123
v_mul_f32 v124, v23, v124
v_mul_f32 v125, v23, v125
v_mul_f32 v126, v23, v126
v_mul_f32 v127, v23, v127
v_cvt_pk_bf16_f32 v118, v124, v125
v_cvt_pk_bf16_f32 v119, v126, v127
s_cmp_eq_u32 s43, 3
s_cbranch_scc0 L_if52
buffer_store_dwordx4 v[240:243], v1, s[24:27], s85 offen offset:0 sc1
buffer_store_dwordx4 v[244:247], v1, s[24:27], s85 offen offset:1024 sc1
buffer_store_dwordx4 v[112:115], v1, s[24:27], s85 offen offset:2048 sc1
buffer_store_dwordx4 v[116:119], v1, s[24:27], s85 offen offset:3072 sc1
v_add3_u32 v96, v8, v240, v241
v_add3_u32 v96, v96, v242, v243
v_add3_u32 v96, v96, v244, v245
v_add3_u32 v96, v96, v246, v247
v_add3_u32 v96, v96, v112, v113
v_add3_u32 v96, v96, v114, v115
v_add3_u32 v96, v96, v116, v117
v_add3_u32 v96, v96, v118, v119
buffer_store_dword v96, v9, s[24:27], s86 offen sc1
L_if52:
v_mfma_f32_16x16x32_bf16 v[64:67], v[32:35], v[144:147], v[64:67]
ds_read_b64_tr_b16 v[48:49], v2 offset:1024
ds_read_b64_tr_b16 v[50:51], v2 offset:5120
v_mfma_f32_16x16x32_bf16 v[68:71], v[32:35], v[148:151], v[68:71]
ds_read_b64_tr_b16 v[52:53], v3 offset:1024
ds_read_b64_tr_b16 v[54:55], v3 offset:5120
v_mfma_f32_16x16x32_bf16 v[72:75], v[36:39], v[144:147], v[72:75]
ds_read_b64_tr_b16 v[56:57], v2 offset:9216
ds_read_b64_tr_b16 v[58:59], v2 offset:13312
s_add_u32 m0, s49, 0xc400
s_add_u32 s46, s55, 0x38000
buffer_load_dwordx4 v17, s[16:19], s46 offen offset:0 lds
v_mfma_f32_16x16x32_bf16 v[76:79], v[36:39], v[148:151], v[76:79]
ds_read_b64_tr_b16 v[60:61], v3 offset:9216
ds_read_b64_tr_b16 v[62:63], v3 offset:13312
s_mov_b64 exec, s[94:95]
ds_write_b128 v21, v[240:243] offset:2048
ds_write_b128 v21, v[244:247] offset:2560
s_mov_b64 exec, -1
v_mfma_f32_16x16x32_bf16 v[80:83], v[40:43], v[144:147], v[80:83]
ds_write_b64 v20, v[112:113] offset:4096
v_mfma_f32_16x16x32_bf16 v[84:87], v[40:43], v[148:151], v[84:87]
ds_write_b64 v20, v[114:115] offset:5120
v_mfma_f32_16x16x32_bf16 v[88:91], v[44:47], v[144:147], v[88:91]
ds_write_b64 v7, v[116:117] offset:4096
v_mfma_f32_16x16x32_bf16 v[92:95], v[44:47], v[148:151], v[92:95]
s_setprio 1
s_waitcnt lgkmcnt(5)
ds_write_b64 v7, v[118:119] offset:5120
v_mfma_f32_16x16x32_bf16 v[64:67], v[48:51], v[152:155], v[64:67]
v_add_u32 v2, 0xffff0000, v2
ds_read_b64_tr_b16 v[32:33], v2 offset:0
ds_read_b64_tr_b16 v[34:35], v2 offset:4096
v_mfma_f32_16x16x32_bf16 v[68:71], v[48:51], v[156:159], v[68:71]
v_add_u32 v3, 0xffff0000, v3
ds_read_b64_tr_b16 v[36:37], v3 offset:0
ds_read_b64_tr_b16 v[38:39], v3 offset:4096
v_mfma_f32_16x16x32_bf16 v[72:75], v[52:55], v[152:155], v[72:75]
ds_read_b64_tr_b16 v[40:41], v2 offset:8192
ds_read_b64_tr_b16 v[42:43], v2 offset:12288
v_mfma_f32_16x16x32_bf16 v[76:79], v[52:55], v[156:159], v[76:79]
ds_read_b64_tr_b16 v[44:45], v3 offset:8192
ds_read_b64_tr_b16 v[46:47], v3 offset:12288
v_mfma_f32_16x16x32_bf16 v[80:83], v[56:59], v[152:155], v[80:83]
v_mfma_f32_16x16x32_bf16 v[84:87], v[56:59], v[156:159], v[84:87]
v_mfma_f32_16x16x32_bf16 v[88:91], v[60:63], v[152:155], v[88:91]
v_mfma_f32_16x16x32_bf16 v[92:95], v[60:63], v[156:159], v[92:95]
s_setprio 0
s_waitcnt lgkmcnt(0)
v_mfma_f32_16x16x32_bf16 v[64:67], v[32:35], v[160:163], v[64:67]
ds_read_b64_tr_b16 v[48:49], v2 offset:1024
ds_read_b64_tr_b16 v[50:51], v2 offset:5120
v_mfma_f32_16x16x32_bf16 v[68:71], v[32:35], v[164:167], v[68:71]
ds_read_b64_tr_b16 v[52:53], v3 offset:1024
ds_read_b64_tr_b16 v[54:55], v3 offset:5120
v_mfma_f32_16x16x32_bf16 v[72:75], v[36:39], v[160:163], v[72:75]
ds_read_b64_tr_b16 v[56:57], v2 offset:9216
ds_read_b64_tr_b16 v[58:59], v2 offset:13312
v_mfma_f32_16x16x32_bf16 v[76:79], v[36:39], v[164:167], v[76:79]
ds_read_b64_tr_b16 v[60:61], v3 offset:9216
ds_read_b64_tr_b16 v[62:63], v3 offset:13312
v_mfma_f32_16x16x32_bf16 v[80:83], v[40:43], v[160:163], v[80:83]
v_mfma_f32_16x16x32_bf16 v[84:87], v[40:43], v[164:167], v[84:87]
v_mfma_f32_16x16x32_bf16 v[88:91], v[44:47], v[160:163], v[88:91]
v_mfma_f32_16x16x32_bf16 v[92:95], v[44:47], v[164:167], v[92:95]
s_waitcnt vmcnt(8) lgkmcnt(0)
s_barrier
s_setprio 3
v_mfma_f32_16x16x32_bf16 v[64:67], v[48:51], v[168:171], v[64:67]
v_add_u32 v2, 0x10000, v2
ds_read_b64_tr_b16 v[32:33], v2 offset:16384
ds_read_b64_tr_b16 v[34:35], v2 offset:20480
s_add_u32 m0, s49, 0x0
s_add_u32 s46, s55, 0x40000
buffer_load_dwordx4 v17, s[16:19], s46 offen offset:0 lds
s_add_u32 m0, s49, 0x400
s_add_u32 s46, s55, 0x48000
buffer_load_dwordx4 v17, s[16:19], s46 offen offset:0 lds
v_mfma_f32_16x16x32_bf16 v[68:71], v[48:51], v[172:175], v[68:71]
v_add_u32 v3, 0x10000, v3
ds_read_b64_tr_b16 v[36:37], v3 offset:16384
ds_read_b64_tr_b16 v[38:39], v3 offset:20480
s_add_u32 m0, s49, 0x10000
s_add_u32 s46, s55, 0x50000
buffer_load_dwordx4 v17, s[16:19], s46 offen offset:0 lds
v_mfma_f32_16x16x32_bf16 v[72:75], v[52:55], v[168:171], v[72:75]
ds_read_b64_tr_b16 v[40:41], v2 offset:24576
ds_read_b64_tr_b16 v[42:43], v2 offset:28672
v_mfma_f32_16x16x32_bf16 v[76:79], v[52:55], v[172:175], v[76:79]
ds_read_b64_tr_b16 v[44:45], v3 offset:24576
ds_read_b64_tr_b16 v[46:47], v3 offset:28672
v_mfma_f32_16x16x32_bf16 v[80:83], v[56:59], v[168:171], v[80:83]
s_add_u32 m0, s49, 0x10400
s_add_u32 s46, s55, 0x58000
buffer_load_dwordx4 v17, s[16:19], s46 offen offset:0 lds
v_mfma_f32_16x16x32_bf16 v[84:87], v[56:59], v[172:175], v[84:87]
v_mfma_f32_16x16x32_bf16 v[88:91], v[60:63], v[168:171], v[88:91]
v_mfma_f32_16x16x32_bf16 v[92:95], v[60:63], v[172:175], v[92:95]
s_setprio 2
s_waitcnt lgkmcnt(0)
v_mfma_f32_16x16x32_bf16 v[64:67], v[32:35], v[176:179], v[64:67]
ds_read_b64_tr_b16 v[48:49], v2 offset:17408
ds_read_b64_tr_b16 v[50:51], v2 offset:21504
v_mfma_f32_16x16x32_bf16 v[68:71], v[32:35], v[180:183], v[68:71]
ds_read_b64_tr_b16 v[52:53], v3 offset:17408
ds_read_b64_tr_b16 v[54:55], v3 offset:21504
v_mfma_f32_16x16x32_bf16 v[72:75], v[36:39], v[176:179], v[72:75]
ds_read_b64_tr_b16 v[56:57], v2 offset:25600
ds_read_b64_tr_b16 v[58:59], v2 offset:29696
v_mfma_f32_16x16x32_bf16 v[76:79], v[36:39], v[180:183], v[76:79]
ds_read_b64_tr_b16 v[60:61], v3 offset:25600
ds_read_b64_tr_b16 v[62:63], v3 offset:29696
v_mfma_f32_16x16x32_bf16 v[80:83], v[40:43], v[176:179], v[80:83]
v_mfma_f32_16x16x32_bf16 v[84:87], v[40:43], v[180:183], v[84:87]
v_mfma_f32_16x16x32_bf16 v[88:91], v[44:47], v[176:179], v[88:91]
v_mfma_f32_16x16x32_bf16 v[92:95], v[44:47], v[180:183], v[92:95]
s_setprio 1
s_waitcnt lgkmcnt(0)
v_mfma_f32_16x16x32_bf16 v[64:67], v[48:51], v[184:187], v[64:67]
ds_read_b64_tr_b16 v[32:33], v2 offset:32768
ds_read_b64_tr_b16 v[34:35], v2 offset:36864
s_cmp_eq_u32 s43, 0
s_cbranch_scc0 L_if53
s_sub_u32 s58, s85, 65536
buffer_load_dwordx4 v[96:99], v1, s[36:39], s58 offen offset:0 sc1
buffer_load_dwordx4 v[100:103], v1, s[36:39], s58 offen offset:1024 sc1
buffer_load_dwordx4 v[104:107], v1, s[36:39], s58 offen offset:2048 sc1
buffer_load_dwordx4 v[108:111], v1, s[36:39], s58 offen offset:3072 sc1
s_sub_u32 s58, s86, 4096
buffer_load_dword v120, v9, s[36:39], s58 offen sc1
L_if53:
v_mfma_f32_16x16x32_bf16 v[68:71], v[48:51], v[188:191], v[68:71]
ds_read_b64_tr_b16 v[36:37], v3 offset:32768
ds_read_b64_tr_b16 v[38:39], v3 offset:36864
v_mfma_f32_16x16x32_bf16 v[72:75], v[52:55], v[184:187], v[72:75]
ds_read_b64_tr_b16 v[40:41], v2 offset:40960
ds_read_b64_tr_b16 v[42:43], v2 offset:45056
v_mfma_f32_16x16x32_bf16 v[76:79], v[52:55], v[188:191], v[76:79]
ds_read_b64_tr_b16 v[44:45], v3 offset:40960
ds_read_b64_tr_b16 v[46:47], v3 offset:45056
v_mfma_f32_16x16x32_bf16 v[80:83], v[56:59], v[184:187], v[80:83]
v_mfma_f32_16x16x32_bf16 v[84:87], v[56:59], v[188:191], v[84:87]
v_mfma_f32_16x16x32_bf16 v[88:91], v[60:63], v[184:187], v[88:91]
v_mfma_f32_16x16x32_bf16 v[92:95], v[60:63], v[188:191], v[92:95]
s_setprio 0
s_waitcnt lgkmcnt(0)
v_mfma_f32_16x16x32_bf16 v[64:67], v[32:35], v[192:195], v[64:67]
ds_read_b64_tr_b16 v[48:49], v2 offset:33792
ds_read_b64_tr_b16 v[50:51], v2 offset:37888
v_mfma_f32_16x16x32_bf16 v[68:71], v[32:35], v[196:199], v[68:71]
ds_read_b64_tr_b16 v[52:53], v3 offset:33792
ds_read_b64_tr_b16 v[54:55], v3 offset:37888
v_mfma_f32_16x16x32_bf16 v[72:75], v[36:39], v[192:195], v[72:75]
ds_read_b64_tr_b16 v[56:57], v2 offset:41984
ds_read_b64_tr_b16 v[58:59], v2 offset:46080
v_mfma_f32_16x16x32_bf16 v[76:79], v[36:39], v[196:199], v[76:79]
ds_read_b64_tr_b16 v[60:61], v3 offset:41984
ds_read_b64_tr_b16 v[62:63], v3 offset:46080
v_mfma_f32_16x16x32_bf16 v[80:83], v[40:43], v[192:195], v[80:83]
v_mfma_f32_16x16x32_bf16 v[84:87], v[40:43], v[196:199], v[84:87]
v_mfma_f32_16x16x32_bf16 v[88:91], v[44:47], v[192:195], v[88:91]
v_mfma_f32_16x16x32_bf16 v[92:95], v[44:47], v[196:199], v[92:95]
s_waitcnt vmcnt(10) lgkmcnt(0)
s_barrier
s_setprio 1
v_mfma_f32_16x16x32_bf16 v[64:67], v[48:51], v[200:203], v[64:67]
ds_read_b64_tr_b16 v[32:33], v2 offset:49152
ds_read_b64_tr_b16 v[34:35], v2 offset:53248
s_add_u32 s58, s90, 0
buffer_load_dwordx4 v[208:211], v1, s[24:27], s58 offen sc1
s_add_u32 s58, s90, 1024
buffer_load_dwordx4 v[212:215], v1, s[24:27], s58 offen sc1
v_mfma_f32_16x16x32_bf16 v[68:71], v[48:51], v[204:207], v[68:71]
ds_read_b64_tr_b16 v[36:37], v3 offset:49152
ds_read_b64_tr_b16 v[38:39], v3 offset:53248
ds_read_b32 v24, v6 offset:256
v_mfma_f32_16x16x32_bf16 v[72:75], v[52:55], v[200:203], v[72:75]
ds_read_b64_tr_b16 v[40:41], v2 offset:50176
ds_read_b64_tr_b16 v[42:43], v2 offset:54272
s_add_u32 s58, s90, 2048
buffer_load_dwordx4 v[216:219], v1, s[24:27], s58 offen sc1
v_mfma_f32_16x16x32_bf16 v[76:79], v[52:55], v[204:207], v[76:79]
ds_read_b64_tr_b16 v[44:45], v3 offset:50176
ds_read_b64_tr_b16 v[46:47], v3 offset:54272
ds_read_b32 v25, v6 offset:384
v_mfma_f32_16x16x32_bf16 v[80:83], v[56:59], v[200:203], v[80:83]
v_mfma_f32_16x16x32_bf16 v[84:87], v[56:59], v[204:207], v[84:87]
v_mfma_f32_16x16x32_bf16 v[88:91], v[60:63], v[200:203], v[88:91]
s_add_u32 s58, s90, 3072
buffer_load_dwordx4 v[220:223], v1, s[24:27], s58 offen sc1
buffer_load_dword v18, v9, s[24:27], s92 offen offset:0 sc1
v_mfma_f32_16x16x32_bf16 v[92:95], v[60:63], v[204:207], v[92:95]
s_setprio 0
s_waitcnt lgkmcnt(1)
v_mfma_f32_16x16x1_4b_f32 v[64:79], v24, v14, v[64:79]
s_waitcnt lgkmcnt(0)
s_nop 1
v_mfma_f32_16x16x1_4b_f32 v[80:95], v25, v14, v[80:95]
s_nop 9
v_mul_f32 v80, v64, v80
v_mul_f32 v81, v65, v81
v_mul_f32 v82, v66, v82
v_mul_f32 v83, v67, v83
v_mul_f32 v64, v10, v64
v_mul_f32 v65, v10, v65
v_mul_f32 v66, v10, v66
v_mul_f32 v67, v10, v67
v_exp_f32 v64, v64
v_exp_f32 v65, v65
v_exp_f32 v66, v66
v_exp_f32 v67, v67
v_fma_f32 v64, v64, v12, v12
v_fma_f32 v65, v65, v12, v12
v_fma_f32 v66, v66, v12, v12
v_fma_f32 v67, v67, v12, v12
v_rcp_f32 v64, v64
v_rcp_f32 v65, v65
v_rcp_f32 v66, v66
v_rcp_f32 v67, v67
v_mul_f32 v80, v80, v64
v_mul_f32 v81, v81, v65
v_mul_f32 v82, v82, v66
v_mul_f32 v83, v83, v67
v_mul_f32 v88, v72, v88
v_mul_f32 v89, v73, v89
v_mul_f32 v90, v74, v90
v_mul_f32 v91, v75, v91
v_mul_f32 v72, v10, v72
v_mul_f32 v73, v10, v73
v_mul_f32 v74, v10, v74
v_mul_f32 v75, v10, v75
v_exp_f32 v72, v72
v_exp_f32 v73, v73
v_exp_f32 v74, v74
v_exp_f32 v75, v75
v_fma_f32 v72, v72, v12, v12
v_fma_f32 v73, v73, v12, v12
v_fma_f32 v74, v74, v12, v12
v_fma_f32 v75, v75, v12, v12
v_rcp_f32 v72, v72
v_rcp_f32 v73, v73
v_rcp_f32 v74, v74
v_rcp_f32 v75, v75
v_mul_f32 v88, v88, v72
v_mul_f32 v89, v89, v73
v_mul_f32 v90, v90, v74
v_mul_f32 v91, v91, v75
v_cvt_pk_bf16_f32 v64, v80, v81
v_cvt_pk_bf16_f32 v65, v82, v83
v_cvt_pk_bf16_f32 v66, v88, v89
v_cvt_pk_bf16_f32 v67, v90, v91
s_add_u32 s58, s59, 0x4000
buffer_store_dwordx4 v[64:67], v1, s[24:27], s58 offen sc1
v_mul_f32 v84, v68, v84
v_mul_f32 v85, v69, v85
v_mul_f32 v86, v70, v86
v_mul_f32 v87, v71, v87
v_mul_f32 v68, v11, v68
v_mul_f32 v69, v11, v69
v_mul_f32 v70, v11, v70
v_mul_f32 v71, v11, v71
v_exp_f32 v68, v68
v_exp_f32 v69, v69
v_exp_f32 v70, v70
v_exp_f32 v71, v71
v_fma_f32 v68, v68, v13, v13
v_fma_f32 v69, v69, v13, v13
v_fma_f32 v70, v70, v13, v13
v_fma_f32 v71, v71, v13, v13
v_rcp_f32 v68, v68
v_rcp_f32 v69, v69
v_rcp_f32 v70, v70
v_rcp_f32 v71, v71
v_mul_f32 v84, v84, v68
v_mul_f32 v85, v85, v69
v_mul_f32 v86, v86, v70
v_mul_f32 v87, v87, v71
v_mul_f32 v92, v76, v92
v_mul_f32 v93, v77, v93
v_mul_f32 v94, v78, v94
v_mul_f32 v95, v79, v95
v_mul_f32 v76, v11, v76
v_mul_f32 v77, v11, v77
v_mul_f32 v78, v11, v78
v_mul_f32 v79, v11, v79
v_exp_f32 v76, v76
v_exp_f32 v77, v77
v_exp_f32 v78, v78
v_exp_f32 v79, v79
v_fma_f32 v76, v76, v13, v13
v_fma_f32 v77, v77, v13, v13
v_fma_f32 v78, v78, v13, v13
v_fma_f32 v79, v79, v13, v13
v_rcp_f32 v76, v76
v_rcp_f32 v77, v77
v_rcp_f32 v78, v78
v_rcp_f32 v79, v79
v_mul_f32 v92, v92, v76
v_mul_f32 v93, v93, v77
v_mul_f32 v94, v94, v78
v_mul_f32 v95, v95, v79
v_cvt_pk_bf16_f32 v68, v84, v85
v_cvt_pk_bf16_f32 v69, v86, v87
v_cvt_pk_bf16_f32 v70, v92, v93
v_cvt_pk_bf16_f32 v71, v94, v95
s_add_u32 s58, s59, 0x4400
buffer_store_dwordx4 v[68:71], v1, s[24:27], s58 offen sc1
v_add3_u32 v72, v64, v65, v66
v_add3_u32 v72, v72, v67, v68
v_add3_u32 v72, v72, v69, v70
v_add_u32 v72, v72, v71
v_mov_b32 v73, v72
s_nop 1
v_permlane32_swap_b32 v72, v73
v_add3_u32 v72, v72, v73, v8
s_mov_b32 exec_hi, 0
buffer_store_dword v72, v9, s[24:27], s60 offen offset:1024 sc1
s_mov_b32 exec_hi, -1
v_mfma_f32_16x16x32_bf16 v[128:131], v[32:35], v[144:147], v[128:131]
ds_read_b64_tr_b16 v[48:49], v2 offset:57344
ds_read_b64_tr_b16 v[50:51], v2 offset:61440
s_add_u32 s58, s90, 4096
buffer_load_dwordx4 v[224:227], v1, s[24:27], s58 offen sc1
v_mfma_f32_16x16x32_bf16 v[132:135], v[32:35], v[148:151], v[132:135]
ds_read_b64_tr_b16 v[52:53], v3 offset:57344
ds_read_b64_tr_b16 v[54:55], v3 offset:61440
s_add_u32 s58, s90, 5120
buffer_load_dwordx4 v[228:231], v1, s[24:27], s58 offen sc1
v_mfma_f32_16x16x32_bf16 v[136:139], v[36:39], v[144:147], v[136:139]
ds_read_b64_tr_b16 v[56:57], v2 offset:58368
ds_read_b64_tr_b16 v[58:59], v2 offset:62464
v_mov_b32 v31, 0xff800000
v_mfma_f32_16x16x32_bf16 v[140:143], v[36:39], v[148:151], v[140:143]
ds_read_b64_tr_b16 v[60:61], v3 offset:58368
ds_read_b64_tr_b16 v[62:63], v3 offset:62464
v_mov_b32 v30, 0xffff0000
v_mfma_f32_16x16x32_bf16 v[128:131], v[40:43], v[152:155], v[128:131]
s_add_u32 s58, s90, 6144
buffer_load_dwordx4 v[232:235], v1, s[24:27], s58 offen sc1
v_mfma_f32_16x16x32_bf16 v[132:135], v[40:43], v[156:159], v[132:135]
v_cndmask_b32 v76, 0, v31, s[64:65]
v_mfma_f32_16x16x32_bf16 v[136:139], v[44:47], v[152:155], v[136:139]
v_mfma_f32_16x16x32_bf16 v[140:143], v[44:47], v[156:159], v[140:143]
v_cndmask_b32 v77, 0, v31, s[66:67]
s_waitcnt vmcnt(19) lgkmcnt(0)
s_barrier
s_setprio 1
v_mfma_f32_16x16x32_bf16 v[128:131], v[48:51], v[160:163], v[128:131]
v_add_u32 v2, 0xffff0000, v2
ds_read_b64_tr_b16 v[32:33], v2 offset:16384
ds_read_b64_tr_b16 v[34:35], v2 offset:20480
s_add_u32 s58, s90, 7168
buffer_load_dwordx4 v[236:239], v1, s[24:27], s58 offen sc1
buffer_load_dword v19, v9, s[24:27], s92 offen offset:256 sc1
v_cndmask_b32 v78, 0, v31, s[32:33]
v_mfma_f32_16x16x32_bf16 v[132:135], v[48:51], v[164:167], v[132:135]
v_add_u32 v3, 0xffff0000, v3
ds_read_b64_tr_b16 v[36:37], v3 offset:16384
ds_read_b64_tr_b16 v[38:39], v3 offset:20480
v_mfma_f32_16x16x32_bf16 v[136:139], v[52:55], v[160:163], v[136:139]
ds_read_b64_tr_b16 v[40:41], v2 offset:17408
ds_read_b64_tr_b16 v[42:43], v2 offset:21504
s_add_u32 m0, s49, 0x14000
s_add_u32 s46, s55, 0x0
buffer_load_dwordx4 v17, s[16:19], s46 offen offset:0 lds
v_cndmask_b32 v79, 0, v31, s[34:35]
s_cmp_eq_u32 s43, 0
s_cbranch_scc0 L_if57
s_waitcnt vmcnt(14)
v_sub_u32 v121, v120, v8
v_add3_u32 v122, v96, v97, v98
v_add3_u32 v122, v122, v99, v100
v_add3_u32 v122, v122, v101, v102
v_add3_u32 v122, v122, v103, v104
v_add3_u32 v122, v122, v105, v106
v_add3_u32 v122, v122, v107, v108
v_add3_u32 v122, v122, v109, v110
v_add_u32 v122, v122, v111
v_cmp_ne_u32 vcc, v121, v122
s_cmp_lg_u32 s38, 0
s_cselect_b64 vcc, vcc, 0
s_cbranch_vccnz L_slow54
L_back55:
ds_write_b64 v7, v[110:111] offset:1024
ds_write_b64 v7, v[108:109] offset:0
ds_write_b64 v20, v[106:107] offset:1024
ds_write_b64 v20, v[104:105] offset:0
s_mov_b64 exec, s[94:95]
ds_write_b128 v21, v[96:99]
ds_write_b128 v21, v[100:103] offset:512
s_mov_b64 exec, -1
L_if57:
v_mfma_f32_16x16x32_bf16 v[140:143], v[52:55], v[164:167], v[140:143]
ds_read_b64_tr_b16 v[44:45], v3 offset:17408
ds_read_b64_tr_b16 v[46:47], v3 offset:21504
v_mfma_f32_16x16x32_bf16 v[128:131], v[56:59], v[168:171], v[128:131]
s_add_u32 m0, s49, 0x14400
s_add_u32 s46, s55, 0x8000
buffer_load_dwordx4 v17, s[16:19], s46 offen offset:0 lds
v_cndmask_b32 v25, 0, v30, s[40:41]
v_mfma_f32_16x16x32_bf16 v[132:135], v[56:59], v[172:175], v[132:135]
v_cndmask_b32 v25, v25, -1, s[98:99]
v_mfma_f32_16x16x32_bf16 v[136:139], v[60:63], v[168:171], v[136:139]
v_mfma_f32_16x16x32_bf16 v[140:143], v[60:63], v[172:175], v[140:143]
s_setprio 0
s_waitcnt lgkmcnt(0)
v_cndmask_b32 v26, 0, v30, s[80:81]
v_mfma_f32_16x16x32_bf16 v[128:131], v[32:35], v[176:179], v[128:131]
ds_read_b64_tr_b16 v[48:49], v2 offset:24576
ds_read_b64_tr_b16 v[50:51], v2 offset:28672
s_add_u32 m0, s49, 0x18000
s_add_u32 s46, s55, 0x10000
buffer_load_dwordx4 v17, s[16:19], s46 offen offset:0 lds
v_mfma_f32_16x16x32_bf16 v[132:135], v[32:35], v[180:183], v[132:135]
ds_read_b64_tr_b16 v[52:53], v3 offset:24576
ds_read_b64_tr_b16 v[54:55], v3 offset:28672
v_cndmask_b32 v26, v26, -1, s[78:79]
v_mfma_f32_16x16x32_bf16 v[136:139], v[36:39], v[176:179], v[136:139]
ds_read_b64_tr_b16 v[56:57], v2 offset:25600
ds_read_b64_tr_b16 v[58:59], v2 offset:29696
v_mul_f32 v27, 0xbe800000, v10
v_mfma_f32_16x16x32_bf16 v[140:143], v[36:39], v[180:183], v[140:143]
ds_read_b64_tr_b16 v[60:61], v3 offset:25600
ds_read_b64_tr_b16 v[62:63], v3 offset:29696
s_add_u32 m0, s49, 0x18400
s_add_u32 s46, s55, 0x18000
buffer_load_dwordx4 v17, s[16:19], s46 offen offset:0 lds
v_mfma_f32_16x16x32_bf16 v[128:131], v[40:43], v[184:187], v[128:131]
s_waitcnt vmcnt(12)
v_add3_u32 v22, v208, v209, v210
v_add3_u32 v22, v22, v211, v212
v_add3_u32 v22, v22, v213, v214
v_add_u32 v22, v22, v215
v_add3_u32 v23, v216, v217, v218
v_add3_u32 v23, v23, v219, v220
v_add3_u32 v23, v23, v221, v222
v_add_u32 v23, v23, v223
s_nop 1
v_permlane32_swap_b32 v22, v23
v_add3_u32 v22, v22, v23, v8
v_cmp_ne_u32 vcc, v22, v18
s_cbranch_vccnz L_slow28
L_back29:
v_mul_f32 v28, 0xbe800000, v11
v_mfma_f32_16x16x32_bf16 v[132:135], v[40:43], v[188:191], v[132:135]
s_add_u32 m0, s49, 0x1c000
s_add_u32 s46, s55, 0x60000
buffer_load_dwordx4 v17, s[16:19], s46 offen offset:0 lds
v_mfma_f32_16x16x32_bf16 v[136:139], v[44:47], v[184:187], v[136:139]
s_waitcnt vmcnt(5)
v_add3_u32 v22, v224, v225, v226
v_add3_u32 v22, v22, v227, v228
v_add3_u32 v22, v22, v229, v230
v_add_u32 v22, v22, v231
v_add3_u32 v23, v232, v233, v234
v_add3_u32 v23, v23, v235, v236
v_add3_u32 v23, v23, v237, v238
v_add_u32 v23, v23, v239
s_nop 1
v_permlane32_swap_b32 v22, v23
v_add3_u32 v22, v22, v23, v8
v_cmp_ne_u32 vcc, v22, v19
s_cbranch_vccnz L_slow31
L_back32:
v_mfma_f32_16x16x32_bf16 v[140:143], v[44:47], v[188:191], v[140:143]
s_add_u32 m0, s49, 0x1c400
s_add_u32 s46, s55, 0x68000
buffer_load_dwordx4 v17, s[16:19], s46 offen offset:0 lds
s_waitcnt lgkmcnt(0)
s_barrier
s_setprio 3
v_mfma_f32_16x16x32_bf16 v[128:131], v[48:51], v[192:195], v[128:131]
s_xor_b32 s58, s3, s44
s_lshl_b32 s58, s58, 6
v_and_b32 v2, 0xffff, v2
v_xor_b32 v2, s58, v2
s_lshl_b32 s58, s44, 13
s_add_u32 s58, s58, 0x0
v_add_u32 v2, s58, v2
v_xor_b32 v3, 32, v2
v_xor_b32 v18, 64, v2
v_xor_b32 v19, 0x60, v2
ds_read_b64_tr_b16 v[32:33], v2 offset:32768
s_add_u32 m0, s49, 0x4000
s_add_u32 s46, s56, 0x0
buffer_load_dwordx4 v17, s[20:23], s46 offen offset:0 lds
v_mfma_f32_16x16x32_bf16 v[132:135], v[48:51], v[196:199], v[132:135]
ds_read_b64_tr_b16 v[34:35], v2 offset:36864
ds_read_b64_tr_b16 v[36:37], v3 offset:32768
ds_read_b32 v64, v6 offset:512
v_mfma_f32_16x16x32_bf16 v[136:139], v[52:55], v[192:195], v[136:139]
ds_read_b64_tr_b16 v[38:39], v3 offset:36864
ds_read_b64_tr_b16 v[40:41], v18 offset:32768
s_add_u32 m0, s49, 0x4400
s_add_u32 s46, s56, 0x8000
buffer_load_dwordx4 v17, s[20:23], s46 offen offset:0 lds
v_mfma_f32_16x16x32_bf16 v[140:143], v[52:55], v[196:199], v[140:143]
ds_read_b64_tr_b16 v[42:43], v18 offset:36864
ds_read_b64_tr_b16 v[44:45], v19 offset:32768
v_mfma_f32_16x16x32_bf16 v[128:131], v[56:59], v[200:203], v[128:131]
ds_read_b64_tr_b16 v[46:47], v19 offset:36864
v_mfma_f32_16x16x32_bf16 v[132:135], v[56:59], v[204:207], v[132:135]
v_mfma_f32_16x16x32_bf16 v[136:139], v[60:63], v[200:203], v[136:139]
v_mfma_f32_16x16x32_bf16 v[140:143], v[60:63], v[204:207], v[140:143]
s_setprio 2
s_waitcnt lgkmcnt(0)
v_mfma_f32_16x16x32_bf16 v[96:99], v[32:35], v[208:211], 0
ds_read_b64_tr_b16 v[48:49], v2 offset:33792
ds_read_b64_tr_b16 v[50:51], v2 offset:37888
s_add_u32 s58, s90, 8192
buffer_load_dwordx4 v[144:147], v1, s[24:27], s58 offen sc1
v_mfma_f32_16x16x1_4b_f32 v[128:143], v64, v14, v[128:143]
s_nop 9
v_cvt_pk_bf16_f32 v248, v128, v129
v_cvt_pk_bf16_f32 v249, v130, v131
v_cvt_pk_bf16_f32 v250, v132, v133
v_cvt_pk_bf16_f32 v251, v134, v135
v_cvt_pk_bf16_f32 v252, v136, v137
v_cvt_pk_bf16_f32 v253, v138, v139
v_cvt_pk_bf16_f32 v254, v140, v141
v_cvt_pk_bf16_f32 v255, v142, v143
v_mfma_f32_16x16x16_bf16 v[80:83], v[240:241], v[248:249], v[76:79]
v_mfma_f32_16x16x16_bf16 v[84:87], v[242:243], v[250:251], v[76:79]
v_mfma_f32_16x16x16_bf16 v[88:91], v[244:245], v[252:253], v[76:79]
v_mfma_f32_16x16x16_bf16 v[92:95], v[246:247], v[254:255], v[76:79]
ds_read_b128 v[240:243], v21
ds_read_b128 v[244:247], v21 offset:512
ds_read_b64_tr_b16 v[128:129], v15 offset:0
v_mfma_f32_16x16x32_bf16 v[100:103], v[32:35], v[212:215], 0
ds_read_b64_tr_b16 v[52:53], v3 offset:33792
ds_read_b64_tr_b16 v[54:55], v3 offset:37888
s_add_u32 s58, s90, 9216
buffer_load_dwordx4 v[148:151], v1, s[24:27], s58 offen sc1
s_add_u32 s58, s90, 10240
buffer_load_dwordx4 v[152:155], v1, s[24:27], s58 offen sc1
ds_read_b64_tr_b16 v[130:131], v15 offset:4096
ds_read_b64_tr_b16 v[132:133], v15 offset:1024
ds_read_b64_tr_b16 v[134:135], v15 offset:5120
ds_read_b64_tr_b16 v[136:137], v16 offset:0
ds_read_b64_tr_b16 v[138:139], v16 offset:4096
ds_read_b64_tr_b16 v[140:141], v16 offset:1024
ds_read_b64_tr_b16 v[142:143], v16 offset:5120
s_waitcnt lgkmcnt(11)
v_mfma_f32_16x16x16_bf16 v[64:67], v[240:241], v[248:249], v[76:79]
v_mfma_f32_16x16x16_bf16 v[68:71], v[242:243], v[250:251], v[76:79]
s_nop 6
v_cndmask_b32 v80, v80, v64, s[98:99]
v_cndmask_b32 v81, v81, v65, s[40:41]
v_cndmask_b32 v82, v82, v66, s[78:79]
v_cndmask_b32 v83, v83, v67, s[80:81]
v_max3_f32 v72, v80, v81, v82
v_mfma_f32_16x16x32_bf16 v[104:107], v[36:39], v[208:211], 0
ds_read_b64_tr_b16 v[56:57], v18 offset:33792
ds_read_b64_tr_b16 v[58:59], v18 offset:37888
s_add_u32 s58, s90, 11264
buffer_load_dwordx4 v[156:159], v1, s[24:27], s58 offen sc1
buffer_load_dword v10, v9, s[24:27], s92 offen offset:512 sc1
v_max_f32 v72, v72, v83
v_cndmask_b32 v84, v84, v68, s[98:99]
v_cndmask_b32 v85, v85, v69, s[40:41]
v_cndmask_b32 v86, v86, v70, s[78:79]
v_cndmask_b32 v87, v87, v71, s[80:81]
v_max3_f32 v73, v84, v85, v86
v_max_f32 v73, v73, v87
s_waitcnt lgkmcnt(12)
v_mfma_f32_16x16x16_bf16 v[64:67], v[244:245], v[252:253], v[76:79]
v_mfma_f32_16x16x16_bf16 v[68:71], v[246:247], v[254:255], v[76:79]
s_nop 6
v_cndmask_b32 v88, v88, v64, s[98:99]
v_cndmask_b32 v89, v89, v65, s[40:41]
v_cndmask_b32 v90, v90, v66, s[78:79]
v_cndmask_b32 v91, v91, v67, s[80:81]
v_mfma_f32_16x16x32_bf16 v[108:111], v[36:39], v[212:215], 0
ds_read_b64_tr_b16 v[60:61], v19 offset:33792
ds_read_b64_tr_b16 v[62:63], v19 offset:37888
s_add_u32 s58, s90, 12288
buffer_load_dwordx4 v[160:163], v1, s[24:27], s58 offen sc1
v_max3_f32 v74, v88, v89, v90
v_max_f32 v74, v74, v91
v_cndmask_b32 v92, v92, v68, s[98:99]
v_cndmask_b32 v93, v93, v69, s[40:41]
v_cndmask_b32 v94, v94, v70, s[78:79]
v_cndmask_b32 v95, v95, v71, s[80:81]
v_max3_f32 v75, v92, v93, v94
v_max_f32 v75, v75, v95
v_permlane32_swap_b32 v72, v74
s_nop 0
v_permlane32_swap_b32 v73, v75
v_max_f32 v72, v72, v74
v_max_f32 v73, v73, v75
v_mov_b32 v64, 0x3f803f80
v_mov_b32 v65, 0x3f803f80
v_permlane16_swap_b32 v72, v73
v_max_f32 v72, v72, v73
v_mov_b32 v73, v72
v_mov_b32 v66, 0x3f803f80
v_mov_b32 v67, 0x3f803f80
v_mfma_f32_16x16x32_bf16 v[112:115], v[40:43], v[208:211], 0
s_add_u32 s58, s90, 13312
buffer_load_dwordx4 v[164:167], v1, s[24:27], s58 offen sc1
v_permlane16_swap_b32 v72, v73
v_mul_f32 v72, v27, v72
v_mul_f32 v73, v28, v73
v_mov_b32 v74, v72
v_mov_b32 v75, v73
s_nop 0
v_permlane32_swap_b32 v72, v74
v_permlane32_swap_b32 v73, v75
v_fma_f32 v80, v80, v27, -v72
v_fma_f32 v81, v81, v27, -v72
v_fma_f32 v82, v82, v27, -v72
v_fma_f32 v83, v83, v27, -v72
v_exp_f32 v80, v80
v_exp_f32 v81, v81
v_exp_f32 v82, v82
v_exp_f32 v83, v83
v_cvt_pk_bf16_f32 v76, v80, v81
v_cvt_pk_bf16_f32 v77, v82, v83
v_mfma_f32_16x16x32_bf16 v[116:119], v[40:43], v[212:215], 0
s_add_u32 s58, s90, 14336
buffer_load_dwordx4 v[168:171], v1, s[24:27], s58 offen sc1
v_and_b32 v80, v25, v76
v_and_b32 v81, v26, v77
v_bfi_b32 v82, v25, 0, v76
v_bfi_b32 v83, v26, 0, v77
v_fma_f32 v88, v88, v27, -v74
v_fma_f32 v89, v89, v27, -v74
v_fma_f32 v90, v90, v27, -v74
v_fma_f32 v91, v91, v27, -v74
v_exp_f32 v88, v88
v_exp_f32 v89, v89
v_exp_f32 v90, v90
v_exp_f32 v91, v91
v_cvt_pk_bf16_f32 v76, v88, v89
v_cvt_pk_bf16_f32 v77, v90, v91
v_and_b32 v88, v25, v76
v_and_b32 v89, v26, v77
v_bfi_b32 v90, v25, 0, v76
v_bfi_b32 v91, v26, 0, v77
s_waitcnt lgkmcnt(10)
v_mfma_f32_16x16x32_bf16 v[240:243], v[128:131], v[80:83], 0
v_mfma_f32_16x16x32_bf16 v[120:123], v[44:47], v[208:211], 0
s_add_u32 s58, s90, 15360
buffer_load_dwordx4 v[172:175], v1, s[24:27], s58 offen sc1
buffer_load_dword v11, v9, s[24:27], s92 offen offset:768 sc1
s_add_u32 s58, s90, 16384
buffer_load_dwordx4 v[176:179], v1, s[24:27], s58 offen sc1
v_mfma_f32_16x16x32_bf16 v[128:131], v[64:67], v[80:83], 0
v_fma_f32 v84, v84, v28, -v73
v_fma_f32 v85, v85, v28, -v73
v_fma_f32 v86, v86, v28, -v73
v_fma_f32 v87, v87, v28, -v73
v_exp_f32 v84, v84
v_exp_f32 v85, v85
v_exp_f32 v86, v86
v_exp_f32 v87, v87
v_cvt_pk_bf16_f32 v76, v84, v85
v_cvt_pk_bf16_f32 v77, v86, v87
v_and_b32 v84, v25, v76
v_and_b32 v85, v26, v77
v_bfi_b32 v86, v25, 0, v76
v_bfi_b32 v87, v26, 0, v77
s_waitcnt lgkmcnt(6)
v_mfma_f32_16x16x32_bf16 v[248:251], v[136:139], v[88:91], 0
v_mfma_f32_16x16x32_bf16 v[136:139], v[64:67], v[88:91], 0
v_fma_f32 v92, v92, v28, -v75
v_fma_f32 v93, v93, v28, -v75
v_mfma_f32_16x16x32_bf16 v[124:127], v[44:47], v[212:215], 0
s_setprio 1
s_waitcnt lgkmcnt(0)
s_add_u32 s58, s90, 17408
buffer_load_dwordx4 v[180:183], v1, s[24:27], s58 offen sc1
v_fma_f32 v94, v94, v28, -v75
v_fma_f32 v95, v95, v28, -v75
v_exp_f32 v92, v92
v_exp_f32 v93, v93
v_exp_f32 v94, v94
v_exp_f32 v95, v95
v_cvt_pk_bf16_f32 v76, v92, v93
v_cvt_pk_bf16_f32 v77, v94, v95
v_and_b32 v92, v25, v76
v_and_b32 v93, v26, v77
v_bfi_b32 v94, v25, 0, v76
v_bfi_b32 v95, v26, 0, v77
v_mfma_f32_16x16x32_bf16 v[244:247], v[132:135], v[84:87], 0
v_mfma_f32_16x16x32_bf16 v[132:135], v[64:67], v[84:87], 0
v_mfma_f32_16x16x32_bf16 v[252:255], v[140:143], v[92:95], 0
v_mfma_f32_16x16x32_bf16 v[140:143], v[64:67], v[92:95], 0
v_rcp_f32 v128, v128
v_mfma_f32_16x16x32_bf16 v[96:99], v[48:51], v[216:219], v[96:99]
ds_read_b64_tr_b16 v[32:33], v2 offset:49152
ds_read_b64_tr_b16 v[34:35], v2 offset:53248
s_add_u32 s58, s90, 18432
buffer_load_dwordx4 v[184:187], v1, s[24:27], s58 offen sc1
s_add_u32 s58, s90, 19456
buffer_load_dwordx4 v[188:191], v1, s[24:27], s58 offen sc1
buffer_load_dword v12, v9, s[24:27], s92 offen offset:1024 sc1
v_mul_f32 v240, v240, v128
v_mul_f32 v241, v241, v128
v_mul_f32 v242, v242, v128
v_mul_f32 v243, v243, v128
v_cvt_pk_bf16_f32 v80, v240, v241
v_cvt_pk_bf16_f32 v81, v242, v243
v_rcp_f32 v136, v136
s_nop 0
v_mul_f32 v248, v248, v136
v_mul_f32 v249, v249, v136
v_mul_f32 v250, v250, v136
v_mul_f32 v251, v251, v136
v_cvt_pk_bf16_f32 v82, v248, v249
v_cvt_pk_bf16_f32 v83, v250, v251
s_add_u32 s58, s59, 0x7000
buffer_store_dwordx4 v[80:83], v1, s[24:27], s58 offen sc1
v_rcp_f32 v132, v132
s_nop 0
v_mul_f32 v244, v244, v132
v_mul_f32 v245, v245, v132
v_mul_f32 v246, v246, v132
v_mul_f32 v247, v247, v132
v_mfma_f32_16x16x32_bf16 v[100:103], v[48:51], v[220:223], v[100:103]
ds_read_b64_tr_b16 v[36:37], v3 offset:49152
ds_read_b64_tr_b16 v[38:39], v3 offset:53248
v_cvt_pk_bf16_f32 v84, v244, v245
v_cvt_pk_bf16_f32 v85, v246, v247
v_rcp_f32 v140, v140
s_nop 0
v_mul_f32 v252, v252, v140
v_mul_f32 v253, v253, v140
v_mul_f32 v254, v254, v140
v_mul_f32 v255, v255, v140
v_cvt_pk_bf16_f32 v86, v252, v253
v_cvt_pk_bf16_f32 v87, v254, v255
s_add_u32 s58, s59, 0x7400
buffer_store_dwordx4 v[84:87], v1, s[24:27], s58 offen sc1
v_add3_u32 v88, v80, v81, v82
v_add3_u32 v88, v88, v83, v84
v_add3_u32 v88, v88, v85, v86
v_add_u32 v88, v88, v87
v_mov_b32 v89, v88
s_nop 1
v_permlane32_swap_b32 v88, v89
v_add3_u32 v88, v88, v89, v8
s_mov_b32 exec_hi, 0
buffer_store_dword v88, v9, s[24:27], s60 offen offset:2048 sc1
s_mov_b32 exec_hi, -1
v_mfma_f32_16x16x32_bf16 v[104:107], v[52:55], v[216:219], v[104:107]
ds_read_b64_tr_b16 v[40:41], v18 offset:49152
ds_read_b64_tr_b16 v[42:43], v18 offset:53248
v_mfma_f32_16x16x32_bf16 v[108:111], v[52:55], v[220:223], v[108:111]
ds_read_b64_tr_b16 v[44:45], v19 offset:49152
ds_read_b64_tr_b16 v[46:47], v19 offset:53248
v_mfma_f32_16x16x32_bf16 v[112:115], v[56:59], v[216:219], v[112:115]
v_mfma_f32_16x16x32_bf16 v[116:119], v[56:59], v[220:223], v[116:119]
v_mfma_f32_16x16x32_bf16 v[120:123], v[60:63], v[216:219], v[120:123]
v_mfma_f32_16x16x32_bf16 v[124:127], v[60:63], v[220:223], v[124:127]
s_setprio 0
s_waitcnt lgkmcnt(0)
v_mfma_f32_16x16x32_bf16 v[96:99], v[32:35], v[224:227], v[96:99]
ds_read_b64_tr_b16 v[48:49], v2 offset:50176
ds_read_b64_tr_b16 v[50:51], v2 offset:54272
v_mfma_f32_16x16x32_bf16 v[100:103], v[32:35], v[228:231], v[100:103]
ds_read_b64_tr_b16 v[52:53], v3 offset:50176
ds_read_b64_tr_b16 v[54:55], v3 offset:54272
v_mfma_f32_16x16x32_bf16 v[104:107], v[36:39], v[224:227], v[104:107]
ds_read_b64_tr_b16 v[56:57], v18 offset:50176
ds_read_b64_tr_b16 v[58:59], v18 offset:54272
v_mfma_f32_16x16x32_bf16 v[108:111], v[36:39], v[228:231], v[108:111]
ds_read_b64_tr_b16 v[60:61], v19 offset:50176
ds_read_b64_tr_b16 v[62:63], v19 offset:54272
v_mfma_f32_16x16x32_bf16 v[112:115], v[40:43], v[224:227], v[112:115]
v_mfma_f32_16x16x32_bf16 v[116:119], v[40:43], v[228:231], v[116:119]
v_mfma_f32_16x16x32_bf16 v[120:123], v[44:47], v[224:227], v[120:123]
v_mfma_f32_16x16x32_bf16 v[124:127], v[44:47], v[228:231], v[124:127]
s_waitcnt vmcnt(22) lgkmcnt(0)
s_barrier
s_setprio 3
v_mfma_f32_16x16x32_bf16 v[96:99], v[48:51], v[232:235], v[96:99]
ds_read_b64_tr_b16 v[32:33], v2 offset:0
ds_read_b64_tr_b16 v[34:35], v2 offset:4096
v_mfma_f32_16x16x32_bf16 v[100:103], v[48:51], v[236:239], v[100:103]
ds_read_b64_tr_b16 v[36:37], v3 offset:0
ds_read_b64_tr_b16 v[38:39], v3 offset:4096
v_mfma_f32_16x16x32_bf16 v[104:107], v[52:55], v[232:235], v[104:107]
ds_read_b64_tr_b16 v[40:41], v18 offset:0
ds_read_b64_tr_b16 v[42:43], v18 offset:4096
v_mfma_f32_16x16x32_bf16 v[108:111], v[52:55], v[236:239], v[108:111]
ds_read_b64_tr_b16 v[44:45], v19 offset:0
ds_read_b64_tr_b16 v[46:47], v19 offset:4096
s_add_u32 m0, s49, 0x8000
s_add_u32 s46, s56, 0x10000
buffer_load_dwordx4 v17, s[20:23], s46 offen offset:0 lds
v_mfma_f32_16x16x32_bf16 v[112:115], v[56:59], v[232:235], v[112:115]
v_mfma_f32_16x16x32_bf16 v[116:119], v[56:59], v[236:239], v[116:119]
v_mfma_f32_16x16x32_bf16 v[120:123], v[60:63], v[232:235], v[120:123]
v_mfma_f32_16x16x32_bf16 v[124:127], v[60:63], v[236:239], v[124:127]
s_setprio 3
s_waitcnt lgkmcnt(0)
s_add_u32 m0, s49, 0x8400
s_add_u32 s46, s56, 0x18000
buffer_load_dwordx4 v17, s[20:23], s46 offen offset:0 lds
s_waitcnt vmcnt(15)
v_add3_u32 v22, v144, v145, v146
v_add3_u32 v22, v22, v147, v148
v_add3_u32 v22, v22, v149, v150
v_add_u32 v22, v22, v151
v_add3_u32 v23, v152, v153, v154
v_add3_u32 v23, v23, v155, v156
v_add3_u32 v23, v23, v157, v158
v_add_u32 v23, v23, v159
s_nop 1
v_permlane32_swap_b32 v22, v23
v_add3_u32 v22, v22, v23, v8
v_cmp_ne_u32 vcc, v22, v10
s_cbranch_vccnz L_slow2
L_back3:
v_mfma_f32_16x16x32_bf16 v[96:99], v[32:35], v[144:147], v[96:99]
ds_read_b64_tr_b16 v[48:49], v2 offset:1024
ds_read_b64_tr_b16 v[50:51], v2 offset:5120
s_add_u32 s58, s90, 20480
buffer_load_dwordx4 v[192:195], v1, s[24:27], s58 offen sc1
v_mfma_f32_16x16x32_bf16 v[100:103], v[32:35], v[148:151], v[100:103]
ds_read_b64_tr_b16 v[52:53], v3 offset:1024
ds_read_b64_tr_b16 v[54:55], v3 offset:5120
v_mfma_f32_16x16x32_bf16 v[104:107], v[36:39], v[144:147], v[104:107]
ds_read_b64_tr_b16 v[56:57], v18 offset:1024
ds_read_b64_tr_b16 v[58:59], v18 offset:5120
v_mfma_f32_16x16x32_bf16 v[108:111], v[36:39], v[148:151], v[108:111]
ds_read_b64_tr_b16 v[60:61], v19 offset:1024
ds_read_b64_tr_b16 v[62:63], v19 offset:5120
v_mfma_f32_16x16x32_bf16 v[112:115], v[40:43], v[144:147], v[112:115]
v_mfma_f32_16x16x32_bf16 v[116:119], v[40:43], v[148:151], v[116:119]
s_add_u32 s58, s90, 21504
buffer_load_dwordx4 v[196:199], v1, s[24:27], s58 offen sc1
v_mfma_f32_16x16x32_bf16 v[120:123], v[44:47], v[144:147], v[120:123]
v_mfma_f32_16x16x32_bf16 v[124:127], v[44:47], v[148:151], v[124:127]
s_setprio 3
s_waitcnt lgkmcnt(0)
v_mfma_f32_16x16x32_bf16 v[96:99], v[48:51], v[152:155], v[96:99]
v_add_u32 v2, 0x10000, v2
ds_read_b64_tr_b16 v[32:33], v2 offset:0
ds_read_b64_tr_b16 v[34:35], v2 offset:4096
v_mfma_f32_16x16x32_bf16 v[100:103], v[48:51], v[156:159], v[100:103]
v_add_u32 v3, 0x10000, v3
ds_read_b64_tr_b16 v[36:37], v3 offset:0
ds_read_b64_tr_b16 v[38:39], v3 offset:4096
s_add_u32 s58, s90, 22528
buffer_load_dwordx4 v[200:203], v1, s[24:27], s58 offen sc1
v_mfma_f32_16x16x32_bf16 v[104:107], v[52:55], v[152:155], v[104:107]
v_add_u32 v18, 0x10000, v18
ds_read_b64_tr_b16 v[40:41], v18 offset:0
ds_read_b64_tr_b16 v[42:43], v18 offset:4096
v_mfma_f32_16x16x32_bf16 v[108:111], v[52:55], v[156:159], v[108:111]
v_add_u32 v19, 0x10000, v19
ds_read_b64_tr_b16 v[44:45], v19 offset:0
ds_read_b64_tr_b16 v[46:47], v19 offset:4096
v_mfma_f32_16x16x32_bf16 v[112:115], v[56:59], v[152:155], v[112:115]
v_mfma_f32_16x16x32_bf16 v[116:119], v[56:59], v[156:159], v[116:119]
s_add_u32 s58, s90, 23552
buffer_load_dwordx4 v[204:207], v1, s[24:27], s58 offen sc1
buffer_load_dword v13, v9, s[24:27], s92 offen offset:1280 sc1
v_mfma_f32_16x16x32_bf16 v[120:123], v[60:63], v[152:155], v[120:123]
v_mfma_f32_16x16x32_bf16 v[124:127], v[60:63], v[156:159], v[124:127]
s_setprio 2
s_waitcnt lgkmcnt(0)
s_waitcnt vmcnt(15)
v_add3_u32 v22, v160, v161, v162
v_add3_u32 v22, v22, v163, v164
v_add3_u32 v22, v22, v165, v166
v_add_u32 v22, v22, v167
v_add3_u32 v23, v168, v169, v170
v_add3_u32 v23, v23, v171, v172
v_add3_u32 v23, v23, v173, v174
v_add_u32 v23, v23, v175
s_nop 1
v_permlane32_swap_b32 v22, v23
v_add3_u32 v22, v22, v23, v8
v_cmp_ne_u32 vcc, v22, v11
s_cbranch_vccnz L_slow5
L_back6:
v_mfma_f32_16x16x32_bf16 v[96:99], v[32:35], v[160:163], v[96:99]
ds_read_b64_tr_b16 v[48:49], v2 offset:1024
ds_read_b64_tr_b16 v[50:51], v2 offset:5120
s_add_u32 s58, s90, 24576
buffer_load_dwordx4 v[208:211], v1, s[24:27], s58 offen sc1
v_mfma_f32_16x16x32_bf16 v[100:103], v[32:35], v[164:167], v[100:103]
ds_read_b64_tr_b16 v[52:53], v3 offset:1024
ds_read_b64_tr_b16 v[54:55], v3 offset:5120
v_mfma_f32_16x16x32_bf16 v[104:107], v[36:39], v[160:163], v[104:107]
ds_read_b64_tr_b16 v[56:57], v18 offset:1024
ds_read_b64_tr_b16 v[58:59], v18 offset:5120
v_mfma_f32_16x16x32_bf16 v[108:111], v[36:39], v[164:167], v[108:111]
ds_read_b64_tr_b16 v[60:61], v19 offset:1024
ds_read_b64_tr_b16 v[62:63], v19 offset:5120
s_add_u32 s58, s90, 25600
buffer_load_dwordx4 v[212:215], v1, s[24:27], s58 offen sc1
buffer_load_dword v4, v9, s[24:27], s92 offen offset:1536 sc1
v_mfma_f32_16x16x32_bf16 v[112:115], v[40:43], v[160:163], v[112:115]
v_mfma_f32_16x16x32_bf16 v[116:119], v[40:43], v[164:167], v[116:119]
v_mfma_f32_16x16x32_bf16 v[120:123], v[44:47], v[160:163], v[120:123]
v_mfma_f32_16x16x32_bf16 v[124:127], v[44:47], v[164:167], v[124:127]
s_setprio 1
s_waitcnt lgkmcnt(0)
s_add_u32 s58, s90, 26624
buffer_load_dwordx4 v[216:219], v1, s[24:27], s58 offen sc1
v_mfma_f32_16x16x32_bf16 v[96:99], v[48:51], v[168:171], v[96:99]
ds_read_b64_tr_b16 v[32:33], v18 offset:16384
ds_read_b64_tr_b16 v[34:35], v18 offset:20480
v_mfma_f32_16x16x32_bf16 v[100:103], v[48:51], v[172:175], v[100:103]
ds_read_b64_tr_b16 v[36:37], v19 offset:16384
ds_read_b64_tr_b16 v[38:39], v19 offset:20480
v_mfma_f32_16x16x32_bf16 v[104:107], v[52:55], v[168:171], v[104:107]
ds_read_b64_tr_b16 v[40:41], v18 offset:17408
ds_read_b64_tr_b16 v[42:43], v18 offset:21504
v_mfma_f32_16x16x32_bf16 v[108:111], v[52:55], v[172:175], v[108:111]
ds_read_b64_tr_b16 v[44:45], v19 offset:17408
ds_read_b64_tr_b16 v[46:47], v19 offset:21504
s_add_u32 s58, s90, 27648
buffer_load_dwordx4 v[220:223], v1, s[24:27], s58 offen sc1
buffer_load_dword v20, v9, s[24:27], s92 offen offset:1792 sc1
v_mfma_f32_16x16x32_bf16 v[112:115], v[56:59], v[168:171], v[112:115]
v_mfma_f32_16x16x32_bf16 v[116:119], v[56:59], v[172:175], v[116:119]
v_mfma_f32_16x16x32_bf16 v[120:123], v[60:63], v[168:171], v[120:123]
v_mfma_f32_16x16x32_bf16 v[124:127], v[60:63], v[172:175], v[124:127]
s_setprio 0
s_waitcnt lgkmcnt(0)
s_waitcnt vmcnt(16)
v_add3_u32 v22, v176, v177, v178
v_add3_u32 v22, v22, v179, v180
v_add3_u32 v22, v22, v181, v182
v_add_u32 v22, v22, v183
v_add3_u32 v23, v184, v185, v186
v_add3_u32 v23, v23, v187, v188
v_add3_u32 v23, v23, v189, v190
v_add_u32 v23, v23, v191
s_nop 1
v_permlane32_swap_b32 v22, v23
v_add3_u32 v22, v22, v23, v8
v_cmp_ne_u32 vcc, v22, v12
s_cbranch_vccnz L_slow8
L_back9:
v_mfma_f32_16x16x32_bf16 v[112:115], v[32:35], v[176:179], v[112:115]
ds_read_b64_tr_b16 v[48:49], v18 offset:32768
ds_read_b64_tr_b16 v[50:51], v18 offset:36864
v_mfma_f32_16x16x32_bf16 v[116:119], v[32:35], v[180:183], v[116:119]
ds_read_b64_tr_b16 v[52:53], v19 offset:32768
ds_read_b64_tr_b16 v[54:55], v19 offset:36864
s_add_u32 s58, s90, 28672
buffer_load_dwordx4 v[224:227], v1, s[24:27], s58 offen sc1
v_mfma_f32_16x16x32_bf16 v[120:123], v[36:39], v[176:179], v[120:123]
ds_read_b64_tr_b16 v[56:57], v18 offset:33792
ds_read_b64_tr_b16 v[58:59], v18 offset:37888
s_add_u32 s58, s90, 29696
buffer_load_dwordx4 v[228:231], v1, s[24:27], s58 offen sc1
v_mfma_f32_16x16x32_bf16 v[124:127], v[36:39], v[180:183], v[124:127]
ds_read_b64_tr_b16 v[60:61], v19 offset:33792
ds_read_b64_tr_b16 v[62:63], v19 offset:37888
v_mfma_f32_16x16x32_bf16 v[112:115], v[40:43], v[184:187], v[112:115]
v_mfma_f32_16x16x32_bf16 v[116:119], v[40:43], v[188:191], v[116:119]
v_mfma_f32_16x16x32_bf16 v[120:123], v[44:47], v[184:187], v[120:123]
s_add_u32 s58, s90, 30720
buffer_load_dwordx4 v[232:235], v1, s[24:27], s58 offen sc1
v_mfma_f32_16x16x32_bf16 v[124:127], v[44:47], v[188:191], v[124:127]
s_waitcnt vmcnt(14) lgkmcnt(0)
s_barrier
s_setprio 3
s_waitcnt vmcnt(9)
v_add3_u32 v22, v192, v193, v194
v_add3_u32 v22, v22, v195, v196
v_add3_u32 v22, v22, v197, v198
v_add_u32 v22, v22, v199
v_add3_u32 v23, v200, v201, v202
v_add3_u32 v23, v23, v203, v204
v_add3_u32 v23, v23, v205, v206
v_add_u32 v23, v23, v207
s_nop 1
v_permlane32_swap_b32 v22, v23
v_add3_u32 v22, v22, v23, v8
v_cmp_ne_u32 vcc, v22, v13
s_cbranch_vccnz L_slow11
L_back12:
v_mfma_f32_16x16x32_bf16 v[112:115], v[48:51], v[192:195], v[112:115]
ds_read_b64_tr_b16 v[32:33], v18 offset:49152
ds_read_b64_tr_b16 v[34:35], v18 offset:53248
s_add_u32 s58, s90, 31744
buffer_load_dwordx4 v[236:239], v1, s[24:27], s58 offen sc1
buffer_load_dword v7, v9, s[24:27], s92 offen offset:2048 sc1
v_mfma_f32_16x16x32_bf16 v[116:119], v[48:51], v[196:199], v[116:119]
ds_read_b64_tr_b16 v[36:37], v19 offset:49152
ds_read_b64_tr_b16 v[38:39], v19 offset:53248
v_mfma_f32_16x16x32_bf16 v[120:123], v[52:55], v[192:195], v[120:123]
ds_read_b64_tr_b16 v[40:41], v18 offset:50176
ds_read_b64_tr_b16 v[42:43], v18 offset:54272
s_add_u32 s58, s90, 32768
buffer_load_dwordx4 v[144:147], v1, s[24:27], s58 offen sc1
v_mfma_f32_16x16x32_bf16 v[124:127], v[52:55], v[196:199], v[124:127]
ds_read_b64_tr_b16 v[44:45], v19 offset:50176
ds_read_b64_tr_b16 v[46:47], v19 offset:54272
v_mfma_f32_16x16x32_bf16 v[112:115], v[56:59], v[200:203], v[112:115]
v_mfma_f32_16x16x32_bf16 v[116:119], v[56:59], v[204:207], v[116:119]
v_mfma_f32_16x16x32_bf16 v[120:123], v[60:63], v[200:203], v[120:123]
s_add_u32 s58, s90, 33792
buffer_load_dwordx4 v[148:151], v1, s[24:27], s58 offen sc1
v_mfma_f32_16x16x32_bf16 v[124:127], v[60:63], v[204:207], v[124:127]
s_setprio 3
s_waitcnt lgkmcnt(0)
s_waitcnt vmcnt(10)
v_add3_u32 v22, v208, v209, v210
v_add_u32 v22, v22, v211
v_add3_u32 v23, v212, v213, v214
v_add_u32 v23, v23, v215
s_nop 1
v_permlane32_swap_b32 v22, v23
v_add3_u32 v22, v22, v23, v8
v_cmp_ne_u32 vcc, v22, v4
s_cbranch_vccnz L_slow14
L_back15:
v_swap_b32 v210, v212
v_swap_b32 v211, v213
s_nop 1
v_mfma_f32_16x16x32_bf16 v[112:115], v[32:35], v[208:211], v[112:115]
v_add_u32 v18, 0xffff0000, v18
ds_read_b64_tr_b16 v[48:49], v18 offset:16384
ds_read_b64_tr_b16 v[50:51], v18 offset:20480
v_mfma_f32_16x16x32_bf16 v[116:119], v[32:35], v[212:215], v[116:119]
v_add_u32 v19, 0xffff0000, v19
ds_read_b64_tr_b16 v[52:53], v19 offset:16384
ds_read_b64_tr_b16 v[54:55], v19 offset:20480
s_add_u32 s58, s90, 34816
buffer_load_dwordx4 v[152:155], v1, s[24:27], s58 offen sc1
v_mfma_f32_16x16x32_bf16 v[120:123], v[36:39], v[208:211], v[120:123]
ds_read_b64_tr_b16 v[56:57], v18 offset:17408
ds_read_b64_tr_b16 v[58:59], v18 offset:21504
v_mfma_f32_16x16x32_bf16 v[124:127], v[36:39], v[212:215], v[124:127]
ds_read_b64_tr_b16 v[60:61], v19 offset:17408
ds_read_b64_tr_b16 v[62:63], v19 offset:21504
s_waitcnt vmcnt(8)
v_add3_u32 v22, v216, v217, v218
v_add_u32 v22, v22, v219
v_add3_u32 v23, v220, v221, v222
v_add_u32 v23, v23, v223
s_nop 1
v_permlane32_swap_b32 v22, v23
v_add3_u32 v22, v22, v23, v8
v_cmp_ne_u32 vcc, v22, v20
s_cbranch_vccnz L_slow17
L_back18:
v_swap_b32 v218, v220
v_swap_b32 v219, v221
s_nop 1
v_mfma_f32_16x16x32_bf16 v[112:115], v[40:43], v[216:219], v[112:115]
s_add_u32 s58, s90, 35840
buffer_load_dwordx4 v[156:159], v1, s[24:27], s58 offen sc1
buffer_load_dword v24, v9, s[24:27], s92 offen offset:2304 sc1
v_mfma_f32_16x16x32_bf16 v[116:119], v[40:43], v[220:223], v[116:119]
v_mfma_f32_16x16x32_bf16 v[120:123], v[44:47], v[216:219], v[120:123]
v_mfma_f32_16x16x32_bf16 v[124:127], v[44:47], v[220:223], v[124:127]
s_setprio 3
s_waitcnt lgkmcnt(0)
s_waitcnt vmcnt(5)
v_add3_u32 v22, v224, v225, v226
v_add3_u32 v22, v22, v227, v228
v_add3_u32 v22, v22, v229, v230
v_add_u32 v22, v22, v231
v_add3_u32 v23, v232, v233, v234
v_add3_u32 v23, v23, v235, v236
v_add3_u32 v23, v23, v237, v238
v_add_u32 v23, v23, v239
s_nop 1
v_permlane32_swap_b32 v22, v23
v_add3_u32 v22, v22, v23, v8
v_cmp_ne_u32 vcc, v22, v7
s_cbranch_vccnz L_slow20
L_back21:
v_mfma_f32_16x16x32_bf16 v[112:115], v[48:51], v[224:227], v[112:115]
ds_read_b64_tr_b16 v[32:33], v18 offset:32768
ds_read_b64_tr_b16 v[34:35], v18 offset:36864
v_mfma_f32_16x16x32_bf16 v[116:119], v[48:51], v[228:231], v[116:119]
ds_read_b64_tr_b16 v[36:37], v19 offset:32768
ds_read_b64_tr_b16 v[38:39], v19 offset:36864
v_mfma_f32_16x16x32_bf16 v[120:123], v[52:55], v[224:227], v[120:123]
ds_read_b64_tr_b16 v[40:41], v18 offset:33792
ds_read_b64_tr_b16 v[42:43], v18 offset:37888
v_and_b32 v88, 0xf0, v1
v_lshlrev_b32 v88, 7, v88
v_bfe_u32 v89, v1, 8, 1
v_mfma_f32_16x16x32_bf16 v[124:127], v[52:55], v[228:231], v[124:127]
ds_read_b64_tr_b16 v[44:45], v19 offset:33792
ds_read_b64_tr_b16 v[46:47], v19 offset:37888
v_lshl_add_u32 v88, v89, 5, v88
v_lshrrev_b32 v89, 9, v1
v_lshl_add_u32 v88, v89, 4, v88
v_mfma_f32_16x16x32_bf16 v[112:115], v[56:59], v[232:235], v[112:115]
buffer_load_dwordx4 v[76:79], v88, s[4:7], s91 offen
v_mfma_f32_16x16x32_bf16 v[116:119], v[56:59], v[236:239], v[116:119]
s_lshl_b32 s58, s43, 12
s_add_u32 s58, s58, 0
s_mul_i32 s57, s44, 49152
s_add_u32 s57, s57, s58
v_add_u32 v90, s57, v1
v_mfma_f32_16x16x32_bf16 v[120:123], v[60:63], v[232:235], v[120:123]
s_lshl_b32 s58, s43, 12
s_add_u32 s58, s58, 0
s_xor_b32 s57, s44, 1
s_mul_i32 s57, s57, 49152
s_add_u32 s57, s57, s58
v_add_u32 v91, s57, v1
v_mfma_f32_16x16x32_bf16 v[124:127], v[60:63], v[236:239], v[124:127]
s_setprio 3
s_waitcnt lgkmcnt(0)
s_mov_b32 s68, 0x7060500
s_mov_b32 s69, 0x7060501
s_mov_b32 s70, 0x7060502
s_mov_b32 s71, 0x7060503
s_waitcnt vmcnt(1)
v_add3_u32 v22, v144, v145, v146
v_add3_u32 v22, v22, v147, v148
v_add3_u32 v22, v22, v149, v150
v_add_u32 v22, v22, v151
v_add3_u32 v23, v152, v153, v154
v_add3_u32 v23, v23, v155, v156
v_add3_u32 v23, v23, v157, v158
v_add_u32 v23, v23, v159
s_nop 1
v_permlane32_swap_b32 v22, v23
v_add3_u32 v22, v22, v23, v8
v_cmp_ne_u32 vcc, v22, v24
s_cbranch_vccnz L_slow23
L_back24:
v_mfma_f32_16x16x32_bf16 v[112:115], v[32:35], v[144:147], v[112:115]
ds_read_b64_tr_b16 v[48:49], v2 offset:16384
ds_read_b64_tr_b16 v[50:51], v2 offset:20480
s_mov_b32 s72, 0x0c0c0400
s_mov_b32 s73, 0x04000c0c
s_add_u32 s93, s93, 0x1000000
s_xor_b32 s61, s93, 0x10000
s_xor_b32 s82, s61, 0x4000
v_mfma_f32_16x16x32_bf16 v[116:119], v[32:35], v[148:151], v[116:119]
ds_read_b64_tr_b16 v[52:53], v3 offset:16384
ds_read_b64_tr_b16 v[54:55], v3 offset:20480
v_mfma_f32_16x16x32_bf16 v[120:123], v[36:39], v[144:147], v[120:123]
ds_read_b64_tr_b16 v[56:57], v2 offset:17408
ds_read_b64_tr_b16 v[58:59], v2 offset:21504
v_mfma_f32_16x16x32_bf16 v[124:127], v[36:39], v[148:151], v[124:127]
ds_read_b64_tr_b16 v[60:61], v3 offset:17408
ds_read_b64_tr_b16 v[62:63], v3 offset:21504
v_mfma_f32_16x16x32_bf16 v[112:115], v[40:43], v[152:155], v[112:115]
v_mfma_f32_16x16x32_bf16 v[116:119], v[40:43], v[156:159], v[116:119]
v_mfma_f32_16x16x32_bf16 v[120:123], v[44:47], v[152:155], v[120:123]
v_mfma_f32_16x16x32_bf16 v[124:127], v[44:47], v[156:159], v[124:127]
s_setprio 3
s_waitcnt lgkmcnt(0)
v_mfma_f32_16x16x32_bf16 v[96:99], v[48:51], v[176:179], v[96:99]
ds_read_b64_tr_b16 v[32:33], v2 offset:32768
ds_read_b64_tr_b16 v[34:35], v2 offset:36864
v_mfma_f32_16x16x32_bf16 v[100:103], v[48:51], v[180:183], v[100:103]
ds_read_b64_tr_b16 v[36:37], v3 offset:32768
ds_read_b64_tr_b16 v[38:39], v3 offset:36864
ds_write_b128 v90, v[116:119] offset:2048
ds_write_b128 v90, v[124:127] offset:3072
v_mfma_f32_16x16x32_bf16 v[104:107], v[52:55], v[176:179], v[104:107]
ds_read_b64_tr_b16 v[40:41], v2 offset:33792
ds_read_b64_tr_b16 v[42:43], v2 offset:37888
v_mfma_f32_16x16x32_bf16 v[108:111], v[52:55], v[180:183], v[108:111]
ds_read_b64_tr_b16 v[44:45], v3 offset:33792
ds_read_b64_tr_b16 v[46:47], v3 offset:37888
s_waitcnt lgkmcnt(4)
s_barrier
ds_read_b128 v[136:139], v91 offset:2048
ds_read_b128 v[140:143], v91 offset:3072
v_mfma_f32_16x16x32_bf16 v[96:99], v[56:59], v[184:187], v[96:99]
v_mfma_f32_16x16x32_bf16 v[100:103], v[56:59], v[188:191], v[100:103]
s_waitcnt lgkmcnt(1)
v_add_f32 v112, v112, v136
v_add_f32 v113, v113, v137
v_add_f32 v114, v114, v138
v_add_f32 v115, v115, v139
v_mfma_f32_16x16x32_bf16 v[104:107], v[60:63], v[184:187], v[104:107]
s_waitcnt lgkmcnt(0)
v_add_f32 v120, v120, v140
v_add_f32 v121, v121, v141
v_add_f32 v122, v122, v142
v_add_f32 v123, v123, v143
v_mfma_f32_16x16x32_bf16 v[108:111], v[60:63], v[188:191], v[108:111]
s_setprio 3
v_cvt_pk_bf16_f32 v112, v112, v113
v_cvt_pk_bf16_f32 v113, v114, v115
v_cvt_pk_bf16_f32 v114, v120, v121
v_cvt_pk_bf16_f32 v115, v122, v123
v_mfma_f32_16x16x32_bf16 v[96:99], v[32:35], v[192:195], v[96:99]
ds_read_b64_tr_b16 v[48:49], v2 offset:49152
ds_read_b64_tr_b16 v[50:51], v2 offset:53248
buffer_store_dwordx4 v[112:115], v1, s[24:27], s93 offen offset:0 sc1
v_add3_u32 v120, v8, v112, v113
v_add3_u32 v120, v120, v114, v115
buffer_store_dword v120, v9, s[24:27], s93 offen offset:1024 sc1
v_mfma_f32_16x16x32_bf16 v[100:103], v[32:35], v[196:199], v[100:103]
ds_read_b64_tr_b16 v[52:53], v3 offset:49152
ds_read_b64_tr_b16 v[54:55], v3 offset:53248
v_mfma_f32_16x16x32_bf16 v[104:107], v[36:39], v[192:195], v[104:107]
ds_read_b64_tr_b16 v[56:57], v2 offset:50176
ds_read_b64_tr_b16 v[58:59], v2 offset:54272
v_mfma_f32_16x16x32_bf16 v[108:111], v[36:39], v[196:199], v[108:111]
ds_read_b64_tr_b16 v[60:61], v3 offset:50176
ds_read_b64_tr_b16 v[62:63], v3 offset:54272
v_mfma_f32_16x16x32_bf16 v[96:99], v[40:43], v[200:203], v[96:99]
v_mfma_f32_16x16x32_bf16 v[100:103], v[40:43], v[204:207], v[100:103]
v_mfma_f32_16x16x32_bf16 v[104:107], v[44:47], v[200:203], v[104:107]
v_mfma_f32_16x16x32_bf16 v[108:111], v[44:47], v[204:207], v[108:111]
s_setprio 2
s_waitcnt lgkmcnt(0)
v_mfma_f32_16x16x32_bf16 v[96:99], v[48:51], v[208:211], v[96:99]
v_add_u32 v2, 0xffff0000, v2
ds_read_b64_tr_b16 v[32:33], v2 offset:16384
ds_read_b64_tr_b16 v[34:35], v2 offset:20480
v_mfma_f32_16x16x32_bf16 v[100:103], v[48:51], v[212:215], v[100:103]
v_add_u32 v3, 0xffff0000, v3
ds_read_b64_tr_b16 v[36:37], v3 offset:16384
ds_read_b64_tr_b16 v[38:39], v3 offset:20480
v_mfma_f32_16x16x32_bf16 v[104:107], v[52:55], v[208:211], v[104:107]
ds_read_b64_tr_b16 v[40:41], v2 offset:17408
ds_read_b64_tr_b16 v[42:43], v2 offset:21504
v_mfma_f32_16x16x32_bf16 v[108:111], v[52:55], v[212:215], v[108:111]
ds_read_b64_tr_b16 v[44:45], v3 offset:17408
ds_read_b64_tr_b16 v[46:47], v3 offset:21504
v_mfma_f32_16x16x32_bf16 v[96:99], v[56:59], v[216:219], v[96:99]
v_mfma_f32_16x16x32_bf16 v[100:103], v[56:59], v[220:223], v[100:103]
v_mfma_f32_16x16x32_bf16 v[104:107], v[60:63], v[216:219], v[104:107]
s_waitcnt vmcnt(2)
v_permlane16_swap_b32 v76, v78
v_mfma_f32_16x16x32_bf16 v[108:111], v[60:63], v[220:223], v[108:111]
s_setprio 1
s_waitcnt lgkmcnt(0)
v_permlane16_swap_b32 v77, v79
v_mfma_f32_16x16x32_bf16 v[96:99], v[32:35], v[224:227], v[96:99]
ds_read_b64_tr_b16 v[48:49], v2 offset:32768
ds_read_b64_tr_b16 v[50:51], v2 offset:36864
v_lshlrev_b32 v64, 16, v76
v_mfma_f32_16x16x32_bf16 v[100:103], v[32:35], v[228:231], v[100:103]
ds_read_b64_tr_b16 v[52:53], v3 offset:32768
ds_read_b64_tr_b16 v[54:55], v3 offset:36864
v_and_b32 v65, 0xffff0000, v76
v_mfma_f32_16x16x32_bf16 v[104:107], v[36:39], v[224:227], v[104:107]
ds_read_b64_tr_b16 v[56:57], v2 offset:33792
ds_read_b64_tr_b16 v[58:59], v2 offset:37888
v_lshlrev_b32 v66, 16, v77
v_mfma_f32_16x16x32_bf16 v[108:111], v[36:39], v[228:231], v[108:111]
ds_read_b64_tr_b16 v[60:61], v3 offset:33792
ds_read_b64_tr_b16 v[62:63], v3 offset:37888
v_and_b32 v67, 0xffff0000, v77
v_mfma_f32_16x16x32_bf16 v[96:99], v[40:43], v[232:235], v[96:99]
v_lshlrev_b32 v68, 16, v78
v_mfma_f32_16x16x32_bf16 v[100:103], v[40:43], v[236:239], v[100:103]
v_and_b32 v69, 0xffff0000, v78
v_mfma_f32_16x16x32_bf16 v[104:107], v[44:47], v[232:235], v[104:107]
v_lshlrev_b32 v70, 16, v79
v_mfma_f32_16x16x32_bf16 v[108:111], v[44:47], v[236:239], v[108:111]
s_setprio 0
s_waitcnt lgkmcnt(0)
v_and_b32 v71, 0xffff0000, v79
v_mfma_f32_16x16x32_bf16 v[96:99], v[48:51], v[144:147], v[96:99]
v_mfma_f32_16x16x32_bf16 v[100:103], v[48:51], v[148:151], v[100:103]
v_mfma_f32_16x16x32_bf16 v[104:107], v[52:55], v[144:147], v[104:107]
v_mfma_f32_16x16x32_bf16 v[108:111], v[52:55], v[148:151], v[108:111]
v_mfma_f32_16x16x32_bf16 v[96:99], v[56:59], v[152:155], v[96:99]
v_mfma_f32_16x16x32_bf16 v[100:103], v[56:59], v[156:159], v[100:103]
v_mfma_f32_16x16x32_bf16 v[104:107], v[60:63], v[152:155], v[104:107]
v_mfma_f32_16x16x32_bf16 v[108:111], v[60:63], v[156:159], v[108:111]
s_nop 5
ds_write_b128 v90, v[100:103] offset:0
s_nop 0
ds_write_b128 v90, v[108:111] offset:1024
buffer_load_dwordx4 v[240:243], v1, s[24:27], s61 offen sc1
buffer_load_dword v248, v9, s[24:27], s61 offen offset:1024 sc1
s_waitcnt lgkmcnt(0)
s_barrier
ds_read_b128 v[128:131], v91 offset:0
ds_read_b128 v[132:135], v91 offset:1024
v_add_f32 v64, v64, v96
v_add_f32 v65, v65, v97
v_add_f32 v66, v66, v98
v_add_f32 v67, v67, v99
s_waitcnt lgkmcnt(1)
v_add_f32 v64, v64, v128
v_add_f32 v65, v65, v129
v_add_f32 v66, v66, v130
v_add_f32 v67, v67, v131
v_add_f32 v68, v68, v104
v_add_f32 v69, v69, v105
v_add_f32 v70, v70, v106
v_add_f32 v71, v71, v107
s_waitcnt lgkmcnt(0)
v_add_f32 v68, v68, v132
v_add_f32 v69, v69, v133
v_add_f32 v70, v70, v134
v_add_f32 v71, v71, v135
s_waitcnt vmcnt(0)
v_sub_u32 v250, v248, v8
v_add3_u32 v251, v240, v241, v242
v_add_u32 v251, v251, v243
v_cmp_ne_u32 vcc, v250, v251
s_cbranch_vccnz L_slow58
L_back59:
v_lshlrev_b32 v128, 16, v240
v_and_b32 v129, 0xffff0000, v240
v_lshlrev_b32 v130, 16, v241
v_and_b32 v131, 0xffff0000, v241
v_lshlrev_b32 v132, 16, v242
v_and_b32 v133, 0xffff0000, v242
v_lshlrev_b32 v134, 16, v243
v_and_b32 v135, 0xffff0000, v243
v_add_f32 v64, v64, v128
v_add_f32 v65, v65, v129
v_add_f32 v66, v66, v130
v_add_f32 v67, v67, v131
v_add_f32 v68, v68, v132
v_add_f32 v69, v69, v133
v_add_f32 v70, v70, v134
v_add_f32 v71, v71, v135
v_cvt_pk_bf16_f32 v72, v64, v65
v_cvt_pk_bf16_f32 v73, v66, v67
v_cvt_pk_bf16_f32 v74, v68, v69
v_cvt_pk_bf16_f32 v75, v70, v71
s_nop 0
v_permlane16_swap_b32 v72, v74
v_permlane16_swap_b32 v73, v75
buffer_store_dwordx4 v[72:75], v88, s[28:31], s91 offen
s_endpgm
L_F:
s_mul_i32 s52, s47, 7
s_add_u32 s52, s52, s48
s_lshl_b32 s52, s52, 7
v_mul_u32_u24 v4, 3584, v26
v_add_u32 v4, v4, v27
s_cmp_eq_u32 s44, 0
s_cselect_b64 s[12:13], s[64:65], s[66:67]
s_add_u32 m0, s49, 0x4000
s_mul_i32 s46, s68, 3584
s_add_u32 s46, s46, s52
buffer_load_dwordx4 v4, s[12:15], s46 offen offset:0 lds
s_add_u32 s46, s46, 0x1bc00
buffer_load_dwordx4 v4, s[12:15], s46 offen offset:1024 lds
s_lshl_b32 s96, s77, 1
s_and_b32 s69, s45, 7
s_add_u32 s96, s96, s69
s_sub_u32 s69, s96, 7
s_cmp_ge_u32 s96, 7
s_cselect_b32 s96, s69, s96
s_lshl_b32 s96, s96, 6
s_add_u32 s69, s96, 64
s_lshl_b32 s57, s44, 6
v_lshrrev_b32 v2, 2, v1
v_xor_b32 v2, s57, v2
v_and_b32 v2, 0x60, v2
v_bfe_u32 v25, v1, 4, 2
v_lshl_add_u32 v2, v25, 3, v2
v_bfe_u32 v25, v1, 6, 3
v_lshl_add_u32 v2, v25, 7, v2
v_lshrrev_b32 v25, 9, v1
v_lshl_add_u32 v2, v25, 11, v2
v_xor_b32 v3, 32, v2
v_lshrrev_b32 v253, 8, v1
v_bfe_u32 v25, v1, 5, 3
v_xor_b32 v25, v253, v25
s_lshl_b32 s57, s43, 12
v_lshl_add_u32 v25, v25, 4, s57
v_and_b32 v23, 0xf0, v1
v_lshl_add_u32 v18, v23, 3, v25
v_xor_b32 v19, 64, v18
s_add_u32 s53, s52, 256
s_add_u32 m0, s49, 0x8000
s_mul_i32 s46, s68, 3584
s_add_u32 s46, s46, s53
buffer_load_dwordx4 v4, s[12:15], s46 offen offset:0 lds
s_add_u32 s46, s46, 0x1bc00
buffer_load_dwordx4 v4, s[12:15], s46 offen offset:1024 lds
s_mul_i32 s54, s47, 14
s_add_u32 s54, s54, s48
s_lshl_b32 s54, s54, 6
s_add_u32 s54, s54, 640
s_and_b32 s58, s43, 1
s_lshl_b32 s58, s58, 2
v_lshl_add_u32 v5, v253, 3, s58
v_bfe_u32 v25, v1, 6, 2
v_add_u32 v5, v5, v25
v_mul_u32_u24 v5, 3584, v5
v_lshrrev_b32 v25, 3, v1
v_and_b32 v25, 0x20, v25
v_xor_b32 v24, v25, v1
v_and_b32 v24, 0x30, v24
v_add_u32 v5, v5, v24
s_lshl_b32 s58, s44, 5
v_xor_b32 v7, s58, v25
v_bfe_u32 v25, v1, 4, 2
v_lshl_add_u32 v7, v25, 3, v7
v_and_b32 v25, 0x3c0, v1
v_add_u32 v7, v7, v25
s_waitcnt lgkmcnt(0)
s_add_u32 s70, s69, 64
s_cmp_ge_u32 s70, 512
s_cselect_b32 s70, 64, s70
s_add_u32 s71, s70, 64
s_cmp_ge_u32 s71, 512
s_cselect_b32 s71, 64, s71
s_add_u32 s72, s71, 64
s_cmp_ge_u32 s72, 512
s_cselect_b32 s72, 64, s72
s_add_u32 s73, s72, 64
s_cmp_ge_u32 s73, 512
s_cselect_b32 s73, 64, s73
s_add_u32 s74, s73, 64
s_cmp_ge_u32 s74, 512
s_cselect_b32 s74, 64, s74
s_add_u32 s75, s74, 64
s_cmp_ge_u32 s75, 512
s_cselect_b32 s75, 64, s75
v_and_b32 v17, 0x70, v4
v_lshrrev_b32 v25, 7, v1
v_lshl_add_u32 v17, v25, 10, v17
v_mov_b32 v22, 0
v_lshrrev_b32 v9, 2, v1
s_lshl2_add_u32 s62, s47, s48
s_lshl4_add_u32 s88, s45, s62
s_lshl3_add_u32 s88, s88, s42
v_lshl_add_u32 v241, v253, 10, v23
v_lshrrev_b32 v25, 1, v253
v_lshlrev_b32 v25, 6, v25
v_lshrrev_b32 v6, 2, v23
s_mul_i32 s58, s44, 640
s_add_u32 s58, s58, 0x20000
v_add3_u32 v6, v6, v25, s58
v_lshrrev_b32 v25, 4, v25
v_lshrrev_b32 v240, 1, v23
s_lshl_b32 s57, s43, 7
s_add_u32 s57, s57, s58
v_add3_u32 v240, v240, v25, s57
v_xor_b32 v253, s89, v253
v_and_b32 v253, 1, v253
v_lshlrev_b32 v253, 4, v253
v_lshl_add_u32 v23, v23, 1, v253
s_mov_b32 s26, 0x1800000
s_mov_b32 s27, 0x20000
s_mov_b32 s18, 0x1c0000
s_mov_b32 s19, 0x20000
s_mov_b32 s22, 0x80000
s_mov_b32 s23, 0x20000
s_mov_b32 s30, 0x200000
s_mov_b32 s31, 0x20000
s_mul_i32 s62, s62, 96
s_add_u32 s62, s62, s44
s_lshl_b32 s62, s62, 8
s_add_u32 s62, s62, 0xb10000
s_and_b32 s57, s43, 1
s_lshr_b32 s58, s43, 1
s_lshl_b32 s82, s57, 5
s_lshl_b32 s83, s58, 13
s_lshl2_add_u32 s58, s58, s57
s_lshl_b32 s58, s58, 7
s_add_u32 s61, s62, s58
s_lshl_b32 s57, s57, 9
s_add_u32 s62, s62, s57
s_lshr_b32 s97, s45, 3
s_and_b32 s76, s45, 7
s_sub_u32 s76, s76, 7
s_min_u32 s76, s76, 1
v_xor_b32 v237, s82, v2
v_add_u32 v236, s83, v237
s_lshl_b32 s58, s82, 8
v_add_u32 v237, s58, v7
v_mov_b32 v224, 0x3f803f80
v_mov_b32 v225, 0x3f803f80
v_mov_b32 v226, 0x3f803f80
v_mov_b32 v227, 0x3f803f80
s_barrier
s_add_u32 m0, s50, 0xc000
s_lshl1_add_u32 s46, s69, s51
buffer_load_dwordx4 v20, s[4:7], s46 offen offset:0 lds
buffer_load_dwordx4 v21, s[4:7], s46 offen offset:1024 lds
s_barrier
s_add_u32 m0, s49, 0x10000
s_mul_i32 s46, s69, 3584
s_add_u32 s46, s46, s52
buffer_load_dwordx4 v4, s[12:15], s46 offen offset:0 lds
s_add_u32 s46, s46, 0x1bc00
buffer_load_dwordx4 v4, s[12:15], s46 offen offset:1024 lds
s_waitcnt vmcnt(6)
s_barrier
ds_read_b128 v[144:147], v18 offset:0
ds_read_b128 v[148:151], v18 offset:2048
ds_read_b64_tr_b16 v[32:33], v2 offset:16384
ds_read_b64_tr_b16 v[34:35], v2 offset:20480
ds_read_b64_tr_b16 v[36:37], v3 offset:16384
ds_read_b64_tr_b16 v[38:39], v3 offset:20480
ds_read_b64_tr_b16 v[40:41], v2 offset:24576
ds_read_b64_tr_b16 v[42:43], v2 offset:28672
ds_read_b64_tr_b16 v[44:45], v3 offset:24576
ds_read_b64_tr_b16 v[46:47], v3 offset:28672
s_setprio 0
s_waitcnt lgkmcnt(6)
v_mfma_f32_16x16x32_bf16 v[96:99], v[32:35], v[144:147], 0
ds_read_b128 v[152:155], v19 offset:0
ds_read_b128 v[156:159], v19 offset:2048
v_mfma_f32_16x16x32_bf16 v[100:103], v[32:35], v[148:151], 0
ds_read_b64_tr_b16 v[48:49], v2 offset:17408
ds_read_b64_tr_b16 v[50:51], v2 offset:21504
s_waitcnt lgkmcnt(8)
v_mfma_f32_16x16x32_bf16 v[104:107], v[36:39], v[144:147], 0
ds_read_b64_tr_b16 v[52:53], v3 offset:17408
ds_read_b64_tr_b16 v[54:55], v3 offset:21504
v_mfma_f32_16x16x32_bf16 v[108:111], v[36:39], v[148:151], 0
ds_read_b64_tr_b16 v[56:57], v2 offset:25600
ds_read_b64_tr_b16 v[58:59], v2 offset:29696
s_waitcnt lgkmcnt(10)
v_mfma_f32_16x16x32_bf16 v[112:115], v[40:43], v[144:147], 0
ds_read_b64_tr_b16 v[60:61], v3 offset:25600
ds_read_b64_tr_b16 v[62:63], v3 offset:29696
s_lshl_b32 s63, s59, 9
s_add_u32 s63, s63, 0xb00000
s_lshl2_add_u32 s59, s59, s47
s_mul_i32 s60, s59, 20
s_mul_i32 s59, s59, 36864
v_mfma_f32_16x16x32_bf16 v[116:119], v[40:43], v[148:151], 0
s_and_b32 s57, s48, 1
s_lshl1_add_u32 s57, s57, s44
s_add_u32 s60, s57, s60
s_lshl_b32 s60, s60, 7
s_add_u32 s60, s60, 0xc00000
s_lshl_b32 s57, s57, 10
s_add_u32 s86, s59, s57
s_add_u32 s59, s86, s57
s_waitcnt lgkmcnt(10)
v_mfma_f32_16x16x32_bf16 v[120:123], v[44:47], v[144:147], 0
s_add_u32 m0, s49, 0x14000
s_mul_i32 s46, s69, 3584
s_add_u32 s46, s46, s53
buffer_load_dwordx4 v4, s[12:15], s46 offen offset:0 lds
s_add_u32 s46, s46, 0x1bc00
buffer_load_dwordx4 v4, s[12:15], s46 offen offset:1024 lds
s_lshr_b32 s57, s2, 5
s_lshl_b32 s57, s57, 7
s_lshl_b32 s58, s43, 13
s_add_u32 s57, s57, s58
s_bfe_u32 s3, s2, 0x10001
s_xor_b32 s3, s3, 1
s_lshl1_add_u32 s58, s3, s44
s_mul_i32 s55, s58, 458752
s_add_u32 s55, s55, s57
s_lshl_b32 s56, s58, 17
s_add_u32 s56, s56, s57
v_mfma_f32_16x16x32_bf16 v[124:127], v[44:47], v[148:151], 0
s_bfe_u32 s58, s2, 0x10002
s_xor_b32 s58, s58, 0
s_and_b32 s57, s2, 1
s_lshl1_add_u32 s58, s58, s57
s_bfe_u32 s57, s2, 0x20003
s_lshl2_add_u32 s58, s58, s57
s_lshl2_add_u32 s58, s58, s43
s_lshl_b32 s91, s58, 5
s_lshl1_add_u32 s58, s58, s3
s_lshl1_add_u32 s58, s58, s44
s_mul_i32 s90, s58, 36864
s_mul_i32 s92, s58, 2560
s_add_u32 s92, s92, 0xc00000
s_sub_u32 s78, s90, 73728
s_sub_u32 s79, s92, 5120
s_lshr_b32 s58, s2, 5
s_add_u32 s91, s91, s44
s_lshl3_add_u32 s91, s91, s58
s_lshl1_add_u32 s91, s91, s3
s_lshl_b32 s91, s91, 6
s_lshl3_add_u32 s93, s2, s42
s_lshl_b32 s93, s93, 12
s_waitcnt vmcnt(6) lgkmcnt(0)
s_barrier
s_setprio 1
v_mfma_f32_16x16x32_bf16 v[96:99], v[48:51], v[152:155], v[96:99]
ds_read_b64_tr_b16 v[32:33], v2 offset:32768
ds_read_b64_tr_b16 v[34:35], v2 offset:36864
v_mfma_f32_16x16x32_bf16 v[100:103], v[48:51], v[156:159], v[100:103]
ds_read_b64_tr_b16 v[36:37], v3 offset:32768
ds_read_b64_tr_b16 v[38:39], v3 offset:36864
v_mfma_f32_16x16x32_bf16 v[104:107], v[52:55], v[152:155], v[104:107]
ds_read_b64_tr_b16 v[40:41], v2 offset:40960
ds_read_b64_tr_b16 v[42:43], v2 offset:45056
v_mfma_f32_16x16x32_bf16 v[108:111], v[52:55], v[156:159], v[108:111]
ds_read_b64_tr_b16 v[44:45], v3 offset:40960
ds_read_b64_tr_b16 v[46:47], v3 offset:45056
v_mfma_f32_16x16x32_bf16 v[112:115], v[56:59], v[152:155], v[112:115]
s_cmp_eq_u32 s76, 0
s_cbranch_scc0 L_if93
s_mov_b32 s58, 0x8000
s_cmp_eq_u32 s97, 0
s_cselect_b32 s58, 0x4000, s58
v_add_u32 v236, s58, v236
s_lshl4_add_u32 s61, s68, s61
ds_read_b64_tr_b16 v[208:209], v236 offset:0
ds_read_b64_tr_b16 v[210:211], v236 offset:4096
ds_read_b64_tr_b16 v[212:213], v236 offset:1024
ds_read_b64_tr_b16 v[214:215], v236 offset:5120
L_if93:
v_mfma_f32_16x16x32_bf16 v[116:119], v[56:59], v[156:159], v[116:119]
v_mfma_f32_16x16x32_bf16 v[120:123], v[60:63], v[152:155], v[120:123]
s_add_u32 m0, s49, 0x18000
s_cmp_lt_u32 s43, 2
s_cselect_b32 s46, s68, s69
s_mul_i32 s46, s46, 3584
s_add_u32 s46, s46, s54
buffer_load_dwordx4 v5, s[12:15], s46 offen offset:0 lds
v_mfma_f32_16x16x32_bf16 v[124:127], v[60:63], v[156:159], v[124:127]
s_setprio 0
s_waitcnt lgkmcnt(0)
s_add_u32 s46, s46, 0x1bc00
buffer_load_dwordx4 v5, s[12:15], s46 offen offset:1024 lds
v_mfma_f32_16x16x32_bf16 v[64:67], v[32:35], v[144:147], 0
ds_read_b64_tr_b16 v[48:49], v2 offset:33792
ds_read_b64_tr_b16 v[50:51], v2 offset:37888
v_mfma_f32_16x16x32_bf16 v[68:71], v[32:35], v[148:151], 0
ds_read_b64_tr_b16 v[52:53], v3 offset:33792
ds_read_b64_tr_b16 v[54:55], v3 offset:37888
v_mfma_f32_16x16x32_bf16 v[72:75], v[36:39], v[144:147], 0
ds_read_b64_tr_b16 v[56:57], v2 offset:41984
ds_read_b64_tr_b16 v[58:59], v2 offset:46080
v_mfma_f32_16x16x32_bf16 v[76:79], v[36:39], v[148:151], 0
ds_read_b64_tr_b16 v[60:61], v3 offset:41984
ds_read_b64_tr_b16 v[62:63], v3 offset:46080
v_mfma_f32_16x16x32_bf16 v[80:83], v[40:43], v[144:147], 0
v_mfma_f32_16x16x32_bf16 v[84:87], v[40:43], v[148:151], 0
v_mfma_f32_16x16x32_bf16 v[88:91], v[44:47], v[144:147], 0
v_mfma_f32_16x16x32_bf16 v[92:95], v[44:47], v[148:151], 0
s_waitcnt vmcnt(4) lgkmcnt(0)
s_barrier
s_setprio 1
v_mfma_f32_16x16x32_bf16 v[64:67], v[48:51], v[152:155], v[64:67]
ds_read_b128 v[160:163], v18 offset:49152
ds_read_b128 v[164:167], v18 offset:51200
v_mfma_f32_16x16x32_bf16 v[68:71], v[48:51], v[156:159], v[68:71]
v_add_u32 v2, 0x10000, v2
ds_read_b64_tr_b16 v[32:33], v2 offset:0
ds_read_b64_tr_b16 v[34:35], v2 offset:4096
v_mfma_f32_16x16x32_bf16 v[72:75], v[52:55], v[152:155], v[72:75]
v_add_u32 v3, 0x10000, v3
ds_read_b64_tr_b16 v[36:37], v3 offset:0
ds_read_b64_tr_b16 v[38:39], v3 offset:4096
v_mfma_f32_16x16x32_bf16 v[76:79], v[52:55], v[156:159], v[76:79]
ds_read_b64_tr_b16 v[40:41], v2 offset:8192
ds_read_b64_tr_b16 v[42:43], v2 offset:12288
v_mfma_f32_16x16x32_bf16 v[80:83], v[56:59], v[152:155], v[80:83]
ds_read_b64_tr_b16 v[44:45], v3 offset:8192
ds_read_b64_tr_b16 v[46:47], v3 offset:12288
v_mfma_f32_16x16x32_bf16 v[84:87], v[56:59], v[156:159], v[84:87]
v_mfma_f32_16x16x32_bf16 v[88:91], v[60:63], v[152:155], v[88:91]
v_mfma_f32_16x16x32_bf16 v[92:95], v[60:63], v[156:159], v[92:95]
s_setprio 0
s_waitcnt lgkmcnt(0)
v_mfma_f32_16x16x32_bf16 v[96:99], v[32:35], v[160:163], v[96:99]
ds_read_b128 v[168:171], v19 offset:49152
ds_read_b128 v[172:175], v19 offset:51200
v_mfma_f32_16x16x32_bf16 v[100:103], v[32:35], v[164:167], v[100:103]
ds_read_b64_tr_b16 v[48:49], v2 offset:1024
ds_read_b64_tr_b16 v[50:51], v2 offset:5120
v_mfma_f32_16x16x32_bf16 v[104:107], v[36:39], v[160:163], v[104:107]
ds_read_b64_tr_b16 v[52:53], v3 offset:1024
ds_read_b64_tr_b16 v[54:55], v3 offset:5120
v_mfma_f32_16x16x32_bf16 v[108:111], v[36:39], v[164:167], v[108:111]
ds_read_b64_tr_b16 v[56:57], v2 offset:9216
ds_read_b64_tr_b16 v[58:59], v2 offset:13312
v_mfma_f32_16x16x32_bf16 v[112:115], v[40:43], v[160:163], v[112:115]
ds_read_b64_tr_b16 v[60:61], v3 offset:9216
ds_read_b64_tr_b16 v[62:63], v3 offset:13312
s_add_u32 m0, s50, 0x1c000
s_lshl1_add_u32 s46, s70, s51
buffer_load_dwordx4 v20, s[4:7], s46 offen offset:0 lds
buffer_load_dwordx4 v21, s[4:7], s46 offen offset:1024 lds
v_mfma_f32_16x16x32_bf16 v[116:119], v[40:43], v[164:167], v[116:119]
global_load_dword v8, v22, s[80:81] sc1
v_mfma_f32_16x16x32_bf16 v[120:123], v[44:47], v[160:163], v[120:123]
v_mfma_f32_16x16x32_bf16 v[124:127], v[44:47], v[164:167], v[124:127]
s_waitcnt vmcnt(5) lgkmcnt(0)
s_barrier
s_setprio 1
v_mfma_f32_16x16x32_bf16 v[96:99], v[48:51], v[168:171], v[96:99]
ds_read_b64_tr_b16 v[32:33], v2 offset:16384
ds_read_b64_tr_b16 v[34:35], v2 offset:20480
v_mfma_f32_16x16x32_bf16 v[100:103], v[48:51], v[172:175], v[100:103]
ds_read_b64_tr_b16 v[36:37], v3 offset:16384
ds_read_b64_tr_b16 v[38:39], v3 offset:20480
v_mfma_f32_16x16x32_bf16 v[104:107], v[52:55], v[168:171], v[104:107]
ds_read_b64_tr_b16 v[40:41], v2 offset:24576
ds_read_b64_tr_b16 v[42:43], v2 offset:28672
v_mfma_f32_16x16x32_bf16 v[108:111], v[52:55], v[172:175], v[108:111]
ds_read_b64_tr_b16 v[44:45], v3 offset:24576
ds_read_b64_tr_b16 v[46:47], v3 offset:28672
v_mfma_f32_16x16x32_bf16 v[112:115], v[56:59], v[168:171], v[112:115]
s_cmp_eq_u32 s76, 1
s_cbranch_scc0 L_if95
s_mov_b32 s58, 0x14000
s_cmp_eq_u32 s97, 0
s_cselect_b32 s58, 0x10000, s58
v_add_u32 v236, s58, v236
s_lshl4_add_u32 s61, s69, s61
ds_read_b64_tr_b16 v[208:209], v236 offset:0
ds_read_b64_tr_b16 v[210:211], v236 offset:4096
ds_read_b64_tr_b16 v[212:213], v236 offset:1024
ds_read_b64_tr_b16 v[214:215], v236 offset:5120
L_if95:
v_mfma_f32_16x16x32_bf16 v[116:119], v[56:59], v[172:175], v[116:119]
v_mfma_f32_16x16x32_bf16 v[120:123], v[60:63], v[168:171], v[120:123]
v_mfma_f32_16x16x32_bf16 v[124:127], v[60:63], v[172:175], v[124:127]
s_setprio 0
s_waitcnt lgkmcnt(0)
v_mfma_f32_16x16x32_bf16 v[64:67], v[32:35], v[160:163], v[64:67]
ds_read_b64_tr_b16 v[48:49], v2 offset:17408
ds_read_b64_tr_b16 v[50:51], v2 offset:21504
s_add_u32 m0, s49, 0x24000
s_mul_i32 s46, s70, 3584
s_add_u32 s46, s46, s52
buffer_load_dwordx4 v4, s[12:15], s46 offen offset:0 lds
s_add_u32 s46, s46, 0x1bc00
buffer_load_dwordx4 v4, s[12:15], s46 offen offset:1024 lds
v_mfma_f32_16x16x32_bf16 v[68:71], v[32:35], v[164:167], v[68:71]
ds_read_b64_tr_b16 v[52:53], v3 offset:17408
ds_read_b64_tr_b16 v[54:55], v3 offset:21504
s_lshl_b32 s58, s88, 10
buffer_load_dwordx4 v[28:31], v1, s[4:7], s58 offen
v_mfma_f32_16x16x32_bf16 v[72:75], v[36:39], v[160:163], v[72:75]
ds_read_b64_tr_b16 v[56:57], v2 offset:25600
ds_read_b64_tr_b16 v[58:59], v2 offset:29696
v_mfma_f32_16x16x32_bf16 v[76:79], v[36:39], v[164:167], v[76:79]
ds_read_b64_tr_b16 v[60:61], v3 offset:25600
ds_read_b64_tr_b16 v[62:63], v3 offset:29696
v_mfma_f32_16x16x32_bf16 v[80:83], v[40:43], v[160:163], v[80:83]
s_add_u32 m0, s49, 0x0
s_mul_i32 s46, s70, 3584
s_add_u32 s46, s46, s53
buffer_load_dwordx4 v4, s[12:15], s46 offen offset:0 lds
v_mfma_f32_16x16x32_bf16 v[84:87], v[40:43], v[164:167], v[84:87]
v_mfma_f32_16x16x32_bf16 v[88:91], v[44:47], v[160:163], v[88:91]
v_mfma_f32_16x16x32_bf16 v[92:95], v[44:47], v[164:167], v[92:95]
s_waitcnt vmcnt(7) lgkmcnt(0)
s_barrier
s_setprio 1
v_mfma_f32_16x16x32_bf16 v[64:67], v[48:51], v[168:171], v[64:67]
v_add_u32 v7, 0x10000, v7
ds_read_b64_tr_b16 v[32:33], v7 offset:32768
ds_read_b64_tr_b16 v[34:35], v7 offset:34816
s_add_u32 s46, s46, 0x1bc00
buffer_load_dwordx4 v4, s[12:15], s46 offen offset:1024 lds
v_mfma_f32_16x16x32_bf16 v[68:71], v[48:51], v[172:175], v[68:71]
ds_read_b64_tr_b16 v[36:37], v7 offset:40960
ds_read_b64_tr_b16 v[38:39], v7 offset:43008
s_add_u32 m0, s49, 0x4000
s_cmp_lt_u32 s43, 2
s_cselect_b32 s46, s70, s71
s_mul_i32 s46, s46, 3584
s_add_u32 s46, s46, s54
buffer_load_dwordx4 v5, s[12:15], s46 offen offset:0 lds
v_mfma_f32_16x16x32_bf16 v[72:75], v[52:55], v[168:171], v[72:75]
ds_read_b64_tr_b16 v[40:41], v7 offset:33792
ds_read_b64_tr_b16 v[42:43], v7 offset:35840
v_mfma_f32_16x16x32_bf16 v[76:79], v[52:55], v[172:175], v[76:79]
ds_read_b64_tr_b16 v[44:45], v7 offset:41984
ds_read_b64_tr_b16 v[46:47], v7 offset:44032
v_mfma_f32_16x16x32_bf16 v[80:83], v[56:59], v[168:171], v[80:83]
s_add_u32 s46, s46, 0x1bc00
buffer_load_dwordx4 v5, s[12:15], s46 offen offset:1024 lds
s_cmp_eq_u32 s76, 0
s_cbranch_scc0 L_if94
v_add_u32 v237, 0x18000, v237
ds_read_b64_tr_b16 v[216:217], v237 offset:0
ds_read_b64_tr_b16 v[218:219], v237 offset:2048
ds_read_b64_tr_b16 v[220:221], v237 offset:1024
ds_read_b64_tr_b16 v[222:223], v237 offset:3072
L_if94:
s_cmp_eq_u32 s76, 1
s_cbranch_scc0 L_if96
v_add_u32 v237, 0x19000, v237
ds_read_b64_tr_b16 v[216:217], v237 offset:0
ds_read_b64_tr_b16 v[218:219], v237 offset:2048
ds_read_b64_tr_b16 v[220:221], v237 offset:1024
ds_read_b64_tr_b16 v[222:223], v237 offset:3072
L_if96:
v_mfma_f32_16x16x32_bf16 v[84:87], v[56:59], v[172:175], v[84:87]
v_mfma_f32_16x16x32_bf16 v[88:91], v[60:63], v[168:171], v[88:91]
v_mfma_f32_16x16x32_bf16 v[92:95], v[60:63], v[172:175], v[92:95]
s_setprio 0
s_waitcnt lgkmcnt(0)
v_mfma_f32_16x16x32_bf16 v[128:131], v[32:35], v[144:147], 0
ds_read_b64_tr_b16 v[48:49], v7 offset:36864
ds_read_b64_tr_b16 v[50:51], v7 offset:38912
v_mfma_f32_16x16x32_bf16 v[228:231], v[224:227], v[208:211], 0
v_mfma_f32_16x16x32_bf16 v[132:135], v[32:35], v[148:151], 0
ds_read_b64_tr_b16 v[52:53], v7 offset:45056
ds_read_b64_tr_b16 v[54:55], v7 offset:47104
v_mfma_f32_16x16x32_bf16 v[228:231], v[224:227], v[212:215], v[228:231]
v_mfma_f32_16x16x32_bf16 v[136:139], v[36:39], v[144:147], 0
ds_read_b64_tr_b16 v[56:57], v7 offset:37888
ds_read_b64_tr_b16 v[58:59], v7 offset:39936
s_waitcnt lgkmcnt(6)
v_mfma_f32_16x16x32_bf16 v[232:235], v[224:227], v[216:219], 0
v_mfma_f32_16x16x32_bf16 v[140:143], v[36:39], v[148:151], 0
ds_read_b64_tr_b16 v[60:61], v7 offset:46080
ds_read_b64_tr_b16 v[62:63], v7 offset:48128
s_waitcnt lgkmcnt(8)
v_mfma_f32_16x16x32_bf16 v[232:235], v[224:227], v[220:223], v[232:235]
v_mfma_f32_16x16x32_bf16 v[128:131], v[40:43], v[152:155], v[128:131]
s_waitcnt vmcnt(7)
v_cmp_eq_u32 vcc, 0, v8
s_cbranch_vccnz L_slow97
L_back98:
v_mfma_f32_16x16x32_bf16 v[132:135], v[40:43], v[156:159], v[132:135]
s_add_u32 m0, s50, 0x8000
s_lshl1_add_u32 s46, s71, s51
buffer_load_dwordx4 v20, s[4:7], s46 offen offset:0 lds
v_lshrrev_b32 v238, 1, v1
v_mfma_f32_16x16x32_bf16 v[136:139], v[44:47], v[152:155], v[136:139]
v_mov_b32 v229, v8
v_mfma_f32_16x16x32_bf16 v[140:143], v[44:47], v[156:159], v[140:143]
v_mov_b32 v233, v8
s_waitcnt vmcnt(1) lgkmcnt(0)
s_barrier
s_setprio 3
v_mfma_f32_16x16x32_bf16 v[128:131], v[48:51], v[160:163], v[128:131]
v_add_u32 v18, 0x10000, v18
ds_read_b128 v[176:179], v18 offset:49152
ds_read_b128 v[180:183], v18 offset:51200
buffer_load_dwordx4 v21, s[4:7], s46 offen offset:1024 lds
s_lshl_b32 s58, s97, 13
s_add_u32 s58, s58, s61
s_mov_b64 exec, 0xffff
buffer_store_dwordx2 v[228:229], v238, s[24:27], s58 offen sc1
s_mov_b64 exec, -1
v_mfma_f32_16x16x32_bf16 v[132:135], v[48:51], v[164:167], v[132:135]
v_add_u32 v2, 0x10000, v2
ds_read_b64_tr_b16 v[32:33], v2 offset:16384
ds_read_b64_tr_b16 v[34:35], v2 offset:20480
s_lshr_b32 s57, s43, 1
s_or_b32 s57, s97, s57
s_cmp_eq_u32 s57, 0
s_cbranch_scc0 L_if100
s_add_u32 s58, s61, 16384
s_mov_b64 exec, 0xffff
buffer_store_dwordx2 v[232:233], v238, s[24:27], s58 offen sc1
s_mov_b64 exec, -1
L_if100:
v_mfma_f32_16x16x32_bf16 v[136:139], v[52:55], v[160:163], v[136:139]
v_add_u32 v3, 0x10000, v3
ds_read_b64_tr_b16 v[36:37], v3 offset:16384
ds_read_b64_tr_b16 v[38:39], v3 offset:20480
v_lshlrev_b32 v244, 16, v28
v_and_b32 v245, 0xffff0000, v28
v_mfma_f32_16x16x32_bf16 v[140:143], v[52:55], v[164:167], v[140:143]
ds_read_b64_tr_b16 v[40:41], v2 offset:24576
ds_read_b64_tr_b16 v[42:43], v2 offset:28672
v_lshlrev_b32 v246, 16, v29
v_and_b32 v247, 0xffff0000, v29
v_mfma_f32_16x16x32_bf16 v[128:131], v[56:59], v[168:171], v[128:131]
ds_read_b64_tr_b16 v[44:45], v3 offset:24576
ds_read_b64_tr_b16 v[46:47], v3 offset:28672
v_lshlrev_b32 v248, 16, v30
v_and_b32 v249, 0xffff0000, v30
v_mfma_f32_16x16x32_bf16 v[132:135], v[56:59], v[172:175], v[132:135]
v_lshlrev_b32 v250, 16, v31
v_and_b32 v251, 0xffff0000, v31
v_mfma_f32_16x16x32_bf16 v[136:139], v[60:63], v[168:171], v[136:139]
s_add_u32 m0, s49, 0xc000
s_mul_i32 s46, s71, 3584
s_add_u32 s46, s46, s52
buffer_load_dwordx4 v4, s[12:15], s46 offen offset:0 lds
v_add_f32 v24, v244, v245
v_add_f32 v25, v246, v247
v_mfma_f32_16x16x32_bf16 v[140:143], v[60:63], v[172:175], v[140:143]
s_setprio 3
s_waitcnt lgkmcnt(0)
v_add_f32 v26, v248, v249
v_add_f32 v27, v250, v251
v_mfma_f32_16x16x32_bf16 v[96:99], v[32:35], v[176:179], v[96:99]
v_add_u32 v19, 0x10000, v19
ds_read_b128 v[184:187], v19 offset:49152
ds_read_b128 v[188:191], v19 offset:51200
v_add_f32 v24, v24, v25
v_add_f32 v26, v26, v27
v_mfma_f32_16x16x32_bf16 v[100:103], v[32:35], v[180:183], v[100:103]
ds_read_b64_tr_b16 v[48:49], v2 offset:17408
ds_read_b64_tr_b16 v[50:51], v2 offset:21504
s_add_u32 s46, s46, 0x1bc00
buffer_load_dwordx4 v4, s[12:15], s46 offen offset:1024 lds
v_add_f32 v24, v24, v26
s_nop 1
v_add_f32_dpp v24, v24, v24 row_shr:1 row_mask:0xf bank_mask:0xf bound_ctrl:0
v_mfma_f32_16x16x32_bf16 v[104:107], v[36:39], v[176:179], v[104:107]
ds_read_b64_tr_b16 v[52:53], v3 offset:17408
ds_read_b64_tr_b16 v[54:55], v3 offset:21504
v_add_f32_dpp v24, v24, v24 row_shr:2 row_mask:0xf bank_mask:0xf bound_ctrl:0
s_nop 1
v_add_f32_dpp v24, v24, v24 row_shr:4 row_mask:0xf bank_mask:0xf bound_ctrl:0
v_mfma_f32_16x16x32_bf16 v[108:111], v[36:39], v[180:183], v[108:111]
ds_read_b64_tr_b16 v[56:57], v2 offset:25600
ds_read_b64_tr_b16 v[58:59], v2 offset:29696
v_add_f32_dpp v24, v24, v24 row_shr:8 row_mask:0xf bank_mask:0xf bound_ctrl:0
v_mfma_f32_16x16x32_bf16 v[112:115], v[40:43], v[176:179], v[112:115]
ds_read_b64_tr_b16 v[60:61], v3 offset:25600
ds_read_b64_tr_b16 v[62:63], v3 offset:29696
s_add_u32 m0, s49, 0x10000
s_mul_i32 s46, s71, 3584
s_add_u32 s46, s46, s53
buffer_load_dwordx4 v4, s[12:15], s46 offen offset:0 lds
v_add_f32_dpp v24, v24, v24 row_bcast:15 row_mask:0xa bank_mask:0xf
s_nop 1
v_add_f32_dpp v24, v24, v24 row_bcast:31 row_mask:0xc bank_mask:0xf
v_mfma_f32_16x16x32_bf16 v[116:119], v[40:43], v[180:183], v[116:119]
v_mul_f32 v24, 0x3b000000, v24
s_nop 0
v_readlane_b32 s84, v24, 63
v_mfma_f32_16x16x32_bf16 v[120:123], v[44:47], v[176:179], v[120:123]
s_nop 0
v_subrev_f32 v244, s84, v244
v_subrev_f32 v245, s84, v245
v_mfma_f32_16x16x32_bf16 v[124:127], v[44:47], v[180:183], v[124:127]
s_setprio 2
s_waitcnt lgkmcnt(0)
s_add_u32 s46, s46, 0x1bc00
buffer_load_dwordx4 v4, s[12:15], s46 offen offset:1024 lds
v_subrev_f32 v246, s84, v246
v_subrev_f32 v247, s84, v247
v_mfma_f32_16x16x32_bf16 v[96:99], v[48:51], v[184:187], v[96:99]
v_add_u32 v2, 0xfffe0000, v2
ds_read_b64_tr_b16 v[32:33], v2 offset:0
ds_read_b64_tr_b16 v[34:35], v2 offset:4096
v_subrev_f32 v248, s84, v248
v_subrev_f32 v249, s84, v249
v_mfma_f32_16x16x32_bf16 v[100:103], v[48:51], v[188:191], v[100:103]
v_add_u32 v3, 0xfffe0000, v3
ds_read_b64_tr_b16 v[36:37], v3 offset:0
ds_read_b64_tr_b16 v[38:39], v3 offset:4096
v_subrev_f32 v250, s84, v250
v_subrev_f32 v251, s84, v251
v_mfma_f32_16x16x32_bf16 v[104:107], v[52:55], v[184:187], v[104:107]
ds_read_b64_tr_b16 v[40:41], v2 offset:8192
ds_read_b64_tr_b16 v[42:43], v2 offset:12288
s_add_u32 m0, s50, 0x14000
s_lshl1_add_u32 s46, s72, s51
buffer_load_dwordx4 v20, s[4:7], s46 offen offset:0 lds
v_mul_f32 v26, v244, v244
v_mul_f32 v27, v245, v245
v_mfma_f32_16x16x32_bf16 v[108:111], v[52:55], v[188:191], v[108:111]
ds_read_b64_tr_b16 v[44:45], v3 offset:8192
ds_read_b64_tr_b16 v[46:47], v3 offset:12288
v_fmac_f32 v26, v246, v246
v_fmac_f32 v27, v247, v247
v_mfma_f32_16x16x32_bf16 v[112:115], v[56:59], v[184:187], v[112:115]
v_fmac_f32 v26, v248, v248
v_fmac_f32 v27, v249, v249
v_mfma_f32_16x16x32_bf16 v[116:119], v[56:59], v[188:191], v[116:119]
buffer_load_dwordx4 v21, s[4:7], s46 offen offset:1024 lds
v_fmac_f32 v26, v250, v250
v_mfma_f32_16x16x32_bf16 v[120:123], v[60:63], v[184:187], v[120:123]
v_fmac_f32 v27, v251, v251
v_add_f32 v26, v26, v27
v_mfma_f32_16x16x32_bf16 v[124:127], v[60:63], v[188:191], v[124:127]
s_setprio 1
s_waitcnt lgkmcnt(0)
v_add_f32_dpp v26, v26, v26 row_shr:1 row_mask:0xf bank_mask:0xf bound_ctrl:0
s_nop 1
v_add_f32_dpp v26, v26, v26 row_shr:2 row_mask:0xf bank_mask:0xf bound_ctrl:0
v_mfma_f32_16x16x32_bf16 v[64:67], v[32:35], v[176:179], v[64:67]
ds_read_b64_tr_b16 v[48:49], v2 offset:1024
ds_read_b64_tr_b16 v[50:51], v2 offset:5120
s_add_u32 m0, s49, 0x18000
s_mul_i32 s46, s72, 3584
s_add_u32 s46, s46, s52
buffer_load_dwordx4 v4, s[12:15], s46 offen offset:0 lds
v_add_f32_dpp v26, v26, v26 row_shr:4 row_mask:0xf bank_mask:0xf bound_ctrl:0
s_nop 1
v_add_f32_dpp v26, v26, v26 row_shr:8 row_mask:0xf bank_mask:0xf bound_ctrl:0
v_mfma_f32_16x16x32_bf16 v[68:71], v[32:35], v[180:183], v[68:71]
ds_read_b64_tr_b16 v[52:53], v3 offset:1024
ds_read_b64_tr_b16 v[54:55], v3 offset:5120
v_add_f32_dpp v26, v26, v26 row_bcast:15 row_mask:0xa bank_mask:0xf
s_nop 1
v_add_f32_dpp v26, v26, v26 row_bcast:31 row_mask:0xc bank_mask:0xf
v_mfma_f32_16x16x32_bf16 v[72:75], v[36:39], v[176:179], v[72:75]
ds_read_b64_tr_b16 v[56:57], v2 offset:9216
ds_read_b64_tr_b16 v[58:59], v2 offset:13312
v_mul_f32 v26, 0x3b000000, v26
v_cvt_pk_bf16_f32 v26, v26, v26
v_mfma_f32_16x16x32_bf16 v[76:79], v[36:39], v[180:183], v[76:79]
ds_read_b64_tr_b16 v[60:61], v3 offset:9216
ds_read_b64_tr_b16 v[62:63], v3 offset:13312
s_add_u32 s46, s46, 0x1bc00
buffer_load_dwordx4 v4, s[12:15], s46 offen offset:1024 lds
v_lshlrev_b32 v26, 16, v26
v_cvt_pk_bf16_f32 v24, v24, v24
v_mfma_f32_16x16x32_bf16 v[80:83], v[40:43], v[176:179], v[80:83]
v_lshlrev_b32 v24, 16, v24
v_add_f32 v26, 0x3727c5ac, v26
v_mfma_f32_16x16x32_bf16 v[84:87], v[40:43], v[180:183], v[84:87]
v_cvt_pk_bf16_f32 v26, v26, v26
v_lshlrev_b32 v26, 16, v26
v_mfma_f32_16x16x32_bf16 v[88:91], v[44:47], v[176:179], v[88:91]
s_mov_b32 m0, 0x20f00
s_lshl3_add_u32 s57, s2, s42
s_lshl_b32 s57, s57, 10
buffer_load_dword v1, s[16:19], s57 offen lds
v_sqrt_f32 v26, v26
s_nop 0
v_cvt_pk_bf16_f32 v26, v26, v26
v_mfma_f32_16x16x32_bf16 v[92:95], v[44:47], v[180:183], v[92:95]
s_setprio 0
s_waitcnt lgkmcnt(0)
v_lshlrev_b32 v26, 16, v26
v_mfma_f32_16x16x32_bf16 v[64:67], v[48:51], v[184:187], v[64:67]
v_add_u32 v7, 0xffff0000, v7
ds_read_b64_tr_b16 v[32:33], v7 offset:16384
ds_read_b64_tr_b16 v[34:35], v7 offset:18432
v_mov_b32 v25, v8
v_mov_b32 v27, v8
v_mfma_f32_16x16x32_bf16 v[68:71], v[48:51], v[188:191], v[68:71]
ds_read_b64_tr_b16 v[36:37], v7 offset:24576
ds_read_b64_tr_b16 v[38:39], v7 offset:26624
s_cmp_lt_u32 s2, 64
s_cbranch_scc0 L_if86
s_mov_b32 m0, 0x20f00
s_lshl3_add_u32 s57, s2, s42
s_lshl_b32 s57, s57, 10
buffer_load_dword v1, s[20:23], s57 offen lds
L_if86:
s_lshl_b32 s58, s88, 4
s_add_u32 s58, s58, 0xb00000
s_mov_b32 exec_lo, 0
s_mov_b32 exec_hi, 0x80000000
buffer_store_dwordx4 v[24:27], v22, s[24:27], s58 offen sc1
s_mov_b64 exec, -1
v_mfma_f32_16x16x32_bf16 v[72:75], v[52:55], v[184:187], v[72:75]
ds_read_b64_tr_b16 v[40:41], v7 offset:17408
ds_read_b64_tr_b16 v[42:43], v7 offset:19456
v_mfma_f32_16x16x32_bf16 v[76:79], v[52:55], v[188:191], v[76:79]
ds_read_b64_tr_b16 v[44:45], v7 offset:25600
ds_read_b64_tr_b16 v[46:47], v7 offset:27648
v_mfma_f32_16x16x32_bf16 v[80:83], v[56:59], v[184:187], v[80:83]
v_mfma_f32_16x16x32_bf16 v[84:87], v[56:59], v[188:191], v[84:87]
v_mfma_f32_16x16x32_bf16 v[88:91], v[60:63], v[184:187], v[88:91]
v_mfma_f32_16x16x32_bf16 v[92:95], v[60:63], v[188:191], v[92:95]
s_waitcnt vmcnt(6) lgkmcnt(0)
s_barrier
s_setprio 3
v_mfma_f32_16x16x32_bf16 v[128:131], v[32:35], v[176:179], v[128:131]
v_add_u32 v18, 0xffff0000, v18
ds_read_b128 v[192:195], v18 offset:32768
ds_read_b128 v[196:199], v18 offset:34816
s_add_u32 m0, s50, 0x0
s_lshl1_add_u32 s46, s73, s51
buffer_load_dwordx4 v20, s[4:7], s46 offen offset:0 lds
v_mfma_f32_16x16x32_bf16 v[132:135], v[32:35], v[180:183], v[132:135]
ds_read_b64_tr_b16 v[48:49], v2 offset:49152
ds_read_b64_tr_b16 v[50:51], v2 offset:53248
buffer_load_dwordx4 v21, s[4:7], s46 offen offset:1024 lds
v_mfma_f32_16x16x32_bf16 v[136:139], v[36:39], v[176:179], v[136:139]
ds_read_b64_tr_b16 v[52:53], v3 offset:49152
ds_read_b64_tr_b16 v[54:55], v3 offset:53248
v_mfma_f32_16x16x32_bf16 v[140:143], v[36:39], v[180:183], v[140:143]
ds_read_b64_tr_b16 v[56:57], v2 offset:57344
ds_read_b64_tr_b16 v[58:59], v2 offset:61440
s_add_u32 m0, s49, 0x1c000
s_mul_i32 s46, s73, 3584
s_add_u32 s46, s46, s52
buffer_load_dwordx4 v4, s[12:15], s46 offen offset:0 lds
v_mfma_f32_16x16x32_bf16 v[128:131], v[40:43], v[184:187], v[128:131]
ds_read_b64_tr_b16 v[60:61], v3 offset:57344
ds_read_b64_tr_b16 v[62:63], v3 offset:61440
v_mfma_f32_16x16x32_bf16 v[132:135], v[40:43], v[188:191], v[132:135]
v_mfma_f32_16x16x32_bf16 v[136:139], v[44:47], v[184:187], v[136:139]
v_mfma_f32_16x16x32_bf16 v[140:143], v[44:47], v[188:191], v[140:143]
s_setprio 3
s_waitcnt lgkmcnt(0)
s_add_u32 s46, s46, 0x1bc00
buffer_load_dwordx4 v4, s[12:15], s46 offen offset:1024 lds
v_mfma_f32_16x16x32_bf16 v[96:99], v[48:51], v[192:195], v[96:99]
v_add_u32 v19, 0xffff0000, v19
ds_read_b128 v[200:203], v19 offset:32768
ds_read_b128 v[204:207], v19 offset:34816
v_mfma_f32_16x16x32_bf16 v[100:103], v[48:51], v[196:199], v[100:103]
ds_read_b64_tr_b16 v[32:33], v2 offset:50176
ds_read_b64_tr_b16 v[34:35], v2 offset:54272
v_mfma_f32_16x16x32_bf16 v[104:107], v[52:55], v[192:195], v[104:107]
ds_read_b64_tr_b16 v[36:37], v3 offset:50176
ds_read_b64_tr_b16 v[38:39], v3 offset:54272
s_add_u32 m0, s50, 0x24000
s_lshl1_add_u32 s46, s74, s51
buffer_load_dwordx4 v20, s[4:7], s46 offen offset:0 lds
v_mfma_f32_16x16x32_bf16 v[108:111], v[52:55], v[196:199], v[108:111]
ds_read_b64_tr_b16 v[40:41], v2 offset:58368
ds_read_b64_tr_b16 v[42:43], v2 offset:62464
v_mfma_f32_16x16x32_bf16 v[112:115], v[56:59], v[192:195], v[112:115]
ds_read_b64_tr_b16 v[44:45], v3 offset:58368
ds_read_b64_tr_b16 v[46:47], v3 offset:62464
v_mfma_f32_16x16x32_bf16 v[116:119], v[56:59], v[196:199], v[116:119]
v_mfma_f32_16x16x32_bf16 v[120:123], v[60:63], v[192:195], v[120:123]
buffer_load_dwordx4 v21, s[4:7], s46 offen offset:1024 lds
v_mfma_f32_16x16x32_bf16 v[124:127], v[60:63], v[196:199], v[124:127]
s_setprio 2
s_waitcnt lgkmcnt(0)
v_mfma_f32_16x16x32_bf16 v[96:99], v[32:35], v[200:203], v[96:99]
v_add_u32 v2, 0x10000, v2
ds_read_b64_tr_b16 v[48:49], v2 offset:0
ds_read_b64_tr_b16 v[50:51], v2 offset:4096
v_mfma_f32_16x16x32_bf16 v[100:103], v[32:35], v[204:207], v[100:103]
v_add_u32 v3, 0x10000, v3
ds_read_b64_tr_b16 v[52:53], v3 offset:0
ds_read_b64_tr_b16 v[54:55], v3 offset:4096
v_mfma_f32_16x16x32_bf16 v[104:107], v[36:39], v[200:203], v[104:107]
ds_read_b64_tr_b16 v[56:57], v2 offset:8192
ds_read_b64_tr_b16 v[58:59], v2 offset:12288
v_mfma_f32_16x16x32_bf16 v[108:111], v[36:39], v[204:207], v[108:111]
ds_read_b64_tr_b16 v[60:61], v3 offset:8192
ds_read_b64_tr_b16 v[62:63], v3 offset:12288
v_mfma_f32_16x16x32_bf16 v[112:115], v[40:43], v[200:203], v[112:115]
v_mfma_f32_16x16x32_bf16 v[116:119], v[40:43], v[204:207], v[116:119]
v_mfma_f32_16x16x32_bf16 v[120:123], v[44:47], v[200:203], v[120:123]
v_mfma_f32_16x16x32_bf16 v[124:127], v[44:47], v[204:207], v[124:127]
s_setprio 1
s_waitcnt lgkmcnt(0)
v_mfma_f32_16x16x32_bf16 v[64:67], v[48:51], v[192:195], v[64:67]
ds_read_b64_tr_b16 v[32:33], v2 offset:1024
ds_read_b64_tr_b16 v[34:35], v2 offset:5120
v_mfma_f32_16x16x32_bf16 v[68:71], v[48:51], v[196:199], v[68:71]
ds_read_b64_tr_b16 v[36:37], v3 offset:1024
ds_read_b64_tr_b16 v[38:39], v3 offset:5120
v_mfma_f32_16x16x32_bf16 v[72:75], v[52:55], v[192:195], v[72:75]
ds_read_b64_tr_b16 v[40:41], v2 offset:9216
ds_read_b64_tr_b16 v[42:43], v2 offset:13312
v_mfma_f32_16x16x32_bf16 v[76:79], v[52:55], v[196:199], v[76:79]
ds_read_b64_tr_b16 v[44:45], v3 offset:9216
ds_read_b64_tr_b16 v[46:47], v3 offset:13312
v_mfma_f32_16x16x32_bf16 v[80:83], v[56:59], v[192:195], v[80:83]
v_mfma_f32_16x16x32_bf16 v[84:87], v[56:59], v[196:199], v[84:87]
v_mfma_f32_16x16x32_bf16 v[88:91], v[60:63], v[192:195], v[88:91]
s_cmp_eq_u32 s43, 0
s_cbranch_scc0 L_if85
s_add_u32 s58, s62, 16384
buffer_load_dwordx4 v[224:227], v241, s[24:27], s58 offen sc1
s_add_u32 s58, s58, 4096
buffer_load_dwordx4 v[232:235], v241, s[24:27], s58 offen sc1
L_if85:
s_add_u32 s58, s83, s62
buffer_load_dwordx4 v[208:211], v241, s[24:27], s58 offen sc1
s_add_u32 s58, s58, 4096
buffer_load_dwordx4 v[216:219], v241, s[24:27], s58 offen sc1
v_mfma_f32_16x16x32_bf16 v[92:95], v[60:63], v[196:199], v[92:95]
s_setprio 0
s_waitcnt lgkmcnt(0)
v_mfma_f32_16x16x32_bf16 v[64:67], v[32:35], v[200:203], v[64:67]
ds_read_b64_tr_b16 v[48:49], v7 offset:20480
ds_read_b64_tr_b16 v[50:51], v7 offset:22528
v_mfma_f32_16x16x32_bf16 v[68:71], v[32:35], v[204:207], v[68:71]
ds_read_b64_tr_b16 v[52:53], v7 offset:28672
ds_read_b64_tr_b16 v[54:55], v7 offset:30720
v_mfma_f32_16x16x32_bf16 v[72:75], v[36:39], v[200:203], v[72:75]
ds_read_b64_tr_b16 v[56:57], v7 offset:21504
ds_read_b64_tr_b16 v[58:59], v7 offset:23552
v_mfma_f32_16x16x32_bf16 v[76:79], v[36:39], v[204:207], v[76:79]
ds_read_b64_tr_b16 v[60:61], v7 offset:29696
ds_read_b64_tr_b16 v[62:63], v7 offset:31744
v_mfma_f32_16x16x32_bf16 v[80:83], v[40:43], v[200:203], v[80:83]
v_mfma_f32_16x16x32_bf16 v[84:87], v[40:43], v[204:207], v[84:87]
v_mfma_f32_16x16x32_bf16 v[88:91], v[44:47], v[200:203], v[88:91]
v_mfma_f32_16x16x32_bf16 v[92:95], v[44:47], v[204:207], v[92:95]
s_waitcnt vmcnt(4) lgkmcnt(0)
s_barrier
s_setprio 3
v_mfma_f32_16x16x32_bf16 v[128:131], v[48:51], v[192:195], v[128:131]
v_add_u32 v18, 0x10000, v18
ds_read_b128 v[144:147], v18 offset:16384
ds_read_b128 v[148:151], v18 offset:18432
s_add_u32 m0, s49, 0x4000
s_mul_i32 s46, s74, 3584
s_add_u32 s46, s46, s52
buffer_load_dwordx4 v4, s[12:15], s46 offen offset:0 lds
v_mfma_f32_16x16x32_bf16 v[132:135], v[48:51], v[196:199], v[132:135]
ds_read_b64_tr_b16 v[32:33], v2 offset:32768
ds_read_b64_tr_b16 v[34:35], v2 offset:36864
s_add_u32 s46, s46, 0x1bc00
buffer_load_dwordx4 v4, s[12:15], s46 offen offset:1024 lds
v_mfma_f32_16x16x32_bf16 v[136:139], v[52:55], v[192:195], v[136:139]
ds_read_b64_tr_b16 v[36:37], v3 offset:32768
ds_read_b64_tr_b16 v[38:39], v3 offset:36864
s_add_u32 m0, s50, 0x8000
s_lshl1_add_u32 s46, s75, s51
buffer_load_dwordx4 v20, s[4:7], s46 offen offset:0 lds
v_mfma_f32_16x16x32_bf16 v[140:143], v[52:55], v[196:199], v[140:143]
ds_read_b64_tr_b16 v[40:41], v2 offset:40960
ds_read_b64_tr_b16 v[42:43], v2 offset:45056
v_mfma_f32_16x16x32_bf16 v[128:131], v[56:59], v[200:203], v[128:131]
ds_read_b64_tr_b16 v[44:45], v3 offset:40960
ds_read_b64_tr_b16 v[46:47], v3 offset:45056
v_mfma_f32_16x16x32_bf16 v[132:135], v[56:59], v[204:207], v[132:135]
v_mfma_f32_16x16x32_bf16 v[136:139], v[60:63], v[200:203], v[136:139]
buffer_load_dwordx4 v21, s[4:7], s46 offen offset:1024 lds
v_mfma_f32_16x16x32_bf16 v[140:143], v[60:63], v[204:207], v[140:143]
s_setprio 2
s_waitcnt lgkmcnt(0)
v_mfma_f32_16x16x32_bf16 v[96:99], v[32:35], v[144:147], v[96:99]
v_add_u32 v19, 0x10000, v19
ds_read_b128 v[152:155], v19 offset:16384
ds_read_b128 v[156:159], v19 offset:18432
v_mfma_f32_16x16x32_bf16 v[100:103], v[32:35], v[148:151], v[100:103]
ds_read_b64_tr_b16 v[48:49], v2 offset:33792
ds_read_b64_tr_b16 v[50:51], v2 offset:37888
v_mfma_f32_16x16x32_bf16 v[104:107], v[36:39], v[144:147], v[104:107]
ds_read_b64_tr_b16 v[52:53], v3 offset:33792
ds_read_b64_tr_b16 v[54:55], v3 offset:37888
s_add_u32 m0, s49, 0xc000
s_mul_i32 s46, s75, 3584
s_add_u32 s46, s46, s52
buffer_load_dwordx4 v4, s[12:15], s46 offen offset:0 lds
v_mfma_f32_16x16x32_bf16 v[108:111], v[36:39], v[148:151], v[108:111]
ds_read_b64_tr_b16 v[56:57], v2 offset:41984
ds_read_b64_tr_b16 v[58:59], v2 offset:46080
v_mfma_f32_16x16x32_bf16 v[112:115], v[40:43], v[144:147], v[112:115]
ds_read_b64_tr_b16 v[60:61], v3 offset:41984
ds_read_b64_tr_b16 v[62:63], v3 offset:46080
v_mfma_f32_16x16x32_bf16 v[116:119], v[40:43], v[148:151], v[116:119]
s_add_u32 s46, s46, 0x1bc00
buffer_load_dwordx4 v4, s[12:15], s46 offen offset:1024 lds
v_mfma_f32_16x16x32_bf16 v[120:123], v[44:47], v[144:147], v[120:123]
v_mfma_f32_16x16x32_bf16 v[124:127], v[44:47], v[148:151], v[124:127]
s_setprio 1
s_waitcnt lgkmcnt(0)
v_mfma_f32_16x16x32_bf16 v[96:99], v[48:51], v[152:155], v[96:99]
v_add_u32 v18, 0xffff0000, v18
ds_read_b128 v[160:163], v18 offset:0
ds_read_b128 v[164:167], v18 offset:2048
v_mfma_f32_16x16x32_bf16 v[100:103], v[48:51], v[156:159], v[100:103]
ds_read_b64_tr_b16 v[32:33], v2 offset:49152
ds_read_b64_tr_b16 v[34:35], v2 offset:53248
s_add_u32 m0, s49, 0x10000
s_mul_i32 s46, s72, 3584
s_add_u32 s46, s46, s53
buffer_load_dwordx4 v4, s[12:15], s46 offen offset:0 lds
v_mfma_f32_16x16x32_bf16 v[104:107], v[52:55], v[152:155], v[104:107]
ds_read_b64_tr_b16 v[36:37], v3 offset:49152
ds_read_b64_tr_b16 v[38:39], v3 offset:53248
v_mfma_f32_16x16x32_bf16 v[108:111], v[52:55], v[156:159], v[108:111]
ds_read_b64_tr_b16 v[40:41], v2 offset:57344
ds_read_b64_tr_b16 v[42:43], v2 offset:61440
v_mfma_f32_16x16x32_bf16 v[112:115], v[56:59], v[152:155], v[112:115]
ds_read_b64_tr_b16 v[44:45], v3 offset:57344
ds_read_b64_tr_b16 v[46:47], v3 offset:61440
buffer_load_dwordx4 v[28:31], v23, s[24:27], s63 offen sc1
s_waitcnt vmcnt(9)
v_min3_u32 v212, v209, v211, v8
v_max3_u32 v213, v209, v211, v8
s_waitcnt vmcnt(8)
v_min3_u32 v212, v217, v219, v212
v_max3_u32 v213, v217, v219, v213
v_cmp_ne_u32 vcc, v212, v213
s_cbranch_vccnz L_slow101
L_back102:
v_add_f32 v208, v208, v216
v_mfma_f32_16x16x32_bf16 v[116:119], v[56:59], v[156:159], v[116:119]
v_add_f32 v210, v210, v218
v_mfma_f32_16x16x32_bf16 v[120:123], v[60:63], v[152:155], v[120:123]
s_nop 0
v_permlane32_swap_b32 v208, v210
v_mfma_f32_16x16x32_bf16 v[124:127], v[60:63], v[156:159], v[124:127]
s_setprio 0
s_waitcnt lgkmcnt(0)
s_add_u32 s46, s46, 0x1bc00
buffer_load_dwordx4 v4, s[12:15], s46 offen offset:1024 lds
v_add_f32 v208, v208, v210
v_mfma_f32_16x16x32_bf16 v[96:99], v[32:35], v[160:163], v[96:99]
v_add_u32 v19, 0xffff0000, v19
ds_read_b128 v[168:171], v19 offset:0
ds_read_b128 v[172:175], v19 offset:2048
v_mov_b32 v210, v208
v_mfma_f32_16x16x32_bf16 v[100:103], v[32:35], v[164:167], v[100:103]
ds_read_b64_tr_b16 v[48:49], v2 offset:50176
ds_read_b64_tr_b16 v[50:51], v2 offset:54272
v_permlane16_swap_b32 v208, v210
v_mfma_f32_16x16x32_bf16 v[104:107], v[36:39], v[160:163], v[104:107]
ds_read_b64_tr_b16 v[52:53], v3 offset:50176
ds_read_b64_tr_b16 v[54:55], v3 offset:54272
v_add_f32 v208, v208, v210
v_mfma_f32_16x16x32_bf16 v[108:111], v[36:39], v[164:167], v[108:111]
ds_read_b64_tr_b16 v[56:57], v2 offset:58368
ds_read_b64_tr_b16 v[58:59], v2 offset:62464
ds_write_b32 v240, v208
v_mfma_f32_16x16x32_bf16 v[112:115], v[40:43], v[160:163], v[112:115]
ds_read_b64_tr_b16 v[60:61], v3 offset:58368
ds_read_b64_tr_b16 v[62:63], v3 offset:62464
s_cmp_eq_u32 s43, 0
s_cbranch_scc0 L_if107
v_min3_u32 v228, v225, v227, v8
v_max3_u32 v229, v225, v227, v8
v_min3_u32 v228, v233, v235, v228
v_max3_u32 v229, v233, v235, v229
v_cmp_ne_u32 vcc, v228, v229
s_cbranch_vccnz L_slow104
L_back105:
v_add_f32 v224, v224, v232
v_add_f32 v226, v226, v234
s_nop 1
v_permlane32_swap_b32 v224, v226
v_add_f32 v224, v224, v226
v_mov_b32 v226, v224
s_nop 1
v_permlane16_swap_b32 v224, v226
v_add_f32 v224, v224, v226
ds_write_b32 v240, v224 offset:512
L_if107:
v_mfma_f32_16x16x32_bf16 v[116:119], v[40:43], v[164:167], v[116:119]
v_mfma_f32_16x16x32_bf16 v[120:123], v[44:47], v[160:163], v[120:123]
v_mfma_f32_16x16x32_bf16 v[124:127], v[44:47], v[164:167], v[124:127]
s_waitcnt vmcnt(3) lgkmcnt(0)
s_barrier
s_setprio 3
v_mfma_f32_16x16x32_bf16 v[96:99], v[48:51], v[168:171], v[96:99]
v_add_u32 v18, 0x20000, v18
ds_read_b128 v[176:179], v18 offset:16384
ds_read_b128 v[180:183], v18 offset:18432
s_add_u32 m0, s49, 0x0
s_mul_i32 s46, s73, 3584
s_add_u32 s46, s46, s53
buffer_load_dwordx4 v4, s[12:15], s46 offen offset:0 lds
v_mfma_f32_16x16x32_bf16 v[100:103], v[48:51], v[172:175], v[100:103]
v_add_u32 v2, 0xffff0000, v2
ds_read_b64_tr_b16 v[32:33], v2 offset:16384
ds_read_b64_tr_b16 v[34:35], v2 offset:20480
s_add_u32 s46, s46, 0x1bc00
buffer_load_dwordx4 v4, s[12:15], s46 offen offset:1024 lds
v_mfma_f32_16x16x32_bf16 v[104:107], v[52:55], v[168:171], v[104:107]
v_add_u32 v3, 0xffff0000, v3
ds_read_b64_tr_b16 v[36:37], v3 offset:16384
ds_read_b64_tr_b16 v[38:39], v3 offset:20480
s_add_u32 m0, s49, 0x14000
s_mul_i32 s46, s74, 3584
s_add_u32 s46, s46, s53
buffer_load_dwordx4 v4, s[12:15], s46 offen offset:0 lds
v_mfma_f32_16x16x32_bf16 v[108:111], v[52:55], v[172:175], v[108:111]
ds_read_b64_tr_b16 v[40:41], v2 offset:24576
ds_read_b64_tr_b16 v[42:43], v2 offset:28672
v_mfma_f32_16x16x32_bf16 v[112:115], v[56:59], v[168:171], v[112:115]
ds_read_b64_tr_b16 v[44:45], v3 offset:24576
ds_read_b64_tr_b16 v[46:47], v3 offset:28672
v_mfma_f32_16x16x32_bf16 v[116:119], v[56:59], v[172:175], v[116:119]
v_mfma_f32_16x16x32_bf16 v[120:123], v[60:63], v[168:171], v[120:123]
s_add_u32 s46, s46, 0x1bc00
buffer_load_dwordx4 v4, s[12:15], s46 offen offset:1024 lds
v_mfma_f32_16x16x32_bf16 v[124:127], v[60:63], v[172:175], v[124:127]
s_setprio 2
s_waitcnt lgkmcnt(0)
v_mfma_f32_16x16x32_bf16 v[96:99], v[32:35], v[176:179], v[96:99]
v_add_u32 v19, 0x20000, v19
ds_read_b128 v[184:187], v19 offset:16384
ds_read_b128 v[188:191], v19 offset:18432
v_mfma_f32_16x16x32_bf16 v[100:103], v[32:35], v[180:183], v[100:103]
ds_read_b64_tr_b16 v[48:49], v2 offset:17408
ds_read_b64_tr_b16 v[50:51], v2 offset:21504
s_add_u32 m0, s49, 0x18000
s_mul_i32 s46, s75, 3584
s_add_u32 s46, s46, s53
buffer_load_dwordx4 v4, s[12:15], s46 offen offset:0 lds
v_mfma_f32_16x16x32_bf16 v[104:107], v[36:39], v[176:179], v[104:107]
ds_read_b64_tr_b16 v[52:53], v3 offset:17408
ds_read_b64_tr_b16 v[54:55], v3 offset:21504
v_mfma_f32_16x16x32_bf16 v[108:111], v[36:39], v[180:183], v[108:111]
ds_read_b64_tr_b16 v[56:57], v2 offset:25600
ds_read_b64_tr_b16 v[58:59], v2 offset:29696
v_mfma_f32_16x16x32_bf16 v[112:115], v[40:43], v[176:179], v[112:115]
ds_read_b64_tr_b16 v[60:61], v3 offset:25600
ds_read_b64_tr_b16 v[62:63], v3 offset:29696
v_mfma_f32_16x16x32_bf16 v[116:119], v[40:43], v[180:183], v[116:119]
s_add_u32 s46, s46, 0x1bc00
buffer_load_dwordx4 v4, s[12:15], s46 offen offset:1024 lds
v_mfma_f32_16x16x32_bf16 v[120:123], v[44:47], v[176:179], v[120:123]
v_mfma_f32_16x16x32_bf16 v[124:127], v[44:47], v[180:183], v[124:127]
s_setprio 1
s_waitcnt lgkmcnt(0)
v_mfma_f32_16x16x32_bf16 v[96:99], v[48:51], v[184:187], v[96:99]
v_add_u32 v18, 0xfffe0000, v18
ds_read_b128 v[192:195], v18 offset:32768
ds_read_b128 v[196:199], v18 offset:34816
v_mfma_f32_16x16x32_bf16 v[100:103], v[48:51], v[188:191], v[100:103]
ds_read_b64_tr_b16 v[32:33], v2 offset:49152
ds_read_b64_tr_b16 v[34:35], v2 offset:53248
s_add_u32 m0, s49, 0x1c000
s_cmp_lt_u32 s43, 2
s_cselect_b32 s46, s72, s73
s_mul_i32 s46, s46, 3584
s_add_u32 s46, s46, s54
buffer_load_dwordx4 v5, s[12:15], s46 offen offset:0 lds
v_mfma_f32_16x16x32_bf16 v[104:107], v[52:55], v[184:187], v[104:107]
ds_read_b64_tr_b16 v[36:37], v3 offset:49152
ds_read_b64_tr_b16 v[38:39], v3 offset:53248
v_mfma_f32_16x16x32_bf16 v[108:111], v[52:55], v[188:191], v[108:111]
ds_read_b64_tr_b16 v[40:41], v2 offset:57344
ds_read_b64_tr_b16 v[42:43], v2 offset:61440
v_mfma_f32_16x16x32_bf16 v[112:115], v[56:59], v[184:187], v[112:115]
ds_read_b64_tr_b16 v[44:45], v3 offset:57344
ds_read_b64_tr_b16 v[46:47], v3 offset:61440
s_waitcnt vmcnt(8)
v_min3_u32 v22, v29, v31, v8
v_max3_u32 v13, v29, v31, v8
v_cmp_ne_u32 vcc, v22, v13
s_cbranch_vccnz L_slow108
L_back109:
v_mfma_f32_16x16x32_bf16 v[116:119], v[56:59], v[188:191], v[116:119]
v_rcp_f32 v29, v30
v_mfma_f32_16x16x32_bf16 v[120:123], v[60:63], v[184:187], v[120:123]
v_mul_f32 v12, v30, v30
v_mfma_f32_16x16x32_bf16 v[124:127], v[60:63], v[188:191], v[124:127]
s_setprio 0
s_waitcnt lgkmcnt(0)
s_add_u32 s46, s46, 0x1bc00
buffer_load_dwordx4 v5, s[12:15], s46 offen offset:1024 lds
v_mul_f32 v10, 0xbfb8aa3b, v29
v_mfma_f32_16x16x32_bf16 v[96:99], v[32:35], v[192:195], v[96:99]
v_add_u32 v19, 0xfffe0000, v19
ds_read_b128 v[200:203], v19 offset:32768
ds_read_b128 v[204:207], v19 offset:34816
v_sub_f32 v14, 0, v28
v_mfma_f32_16x16x32_bf16 v[100:103], v[32:35], v[196:199], v[100:103]
ds_read_b64_tr_b16 v[48:49], v2 offset:50176
ds_read_b64_tr_b16 v[50:51], v2 offset:54272
v_mov_b32 v13, v12
v_mfma_f32_16x16x32_bf16 v[104:107], v[36:39], v[192:195], v[104:107]
ds_read_b64_tr_b16 v[52:53], v3 offset:50176
ds_read_b64_tr_b16 v[54:55], v3 offset:54272
v_mov_b32 v11, v10
v_mfma_f32_16x16x32_bf16 v[108:111], v[36:39], v[196:199], v[108:111]
ds_read_b64_tr_b16 v[56:57], v2 offset:58368
ds_read_b64_tr_b16 v[58:59], v2 offset:62464
v_mfma_f32_16x16x32_bf16 v[112:115], v[40:43], v[192:195], v[112:115]
ds_read_b64_tr_b16 v[60:61], v3 offset:58368
ds_read_b64_tr_b16 v[62:63], v3 offset:62464
v_permlane16_swap_b32 v12, v13
v_mfma_f32_16x16x32_bf16 v[116:119], v[40:43], v[196:199], v[116:119]
v_permlane16_swap_b32 v10, v11
v_mfma_f32_16x16x32_bf16 v[120:123], v[44:47], v[192:195], v[120:123]
v_mfma_f32_16x16x32_bf16 v[124:127], v[44:47], v[196:199], v[124:127]
s_waitcnt vmcnt(6) lgkmcnt(0)
s_barrier
s_setprio 1
v_mfma_f32_16x16x32_bf16 v[96:99], v[48:51], v[200:203], v[96:99]
v_add_u32 v2, 0x10000, v2
ds_read_b64_tr_b16 v[32:33], v2 offset:0
ds_read_b64_tr_b16 v[34:35], v2 offset:4096
s_add_u32 m0, s49, 0x4000
s_cmp_lt_u32 s43, 2
s_cselect_b32 s46, s74, s75
s_mul_i32 s46, s46, 3584
s_add_u32 s46, s46, s54
buffer_load_dwordx4 v5, s[12:15], s46 offen offset:0 lds
ds_read_b32 v24, v6 offset:0
v_mfma_f32_16x16x32_bf16 v[100:103], v[48:51], v[204:207], v[100:103]
v_add_u32 v3, 0x10000, v3
ds_read_b64_tr_b16 v[36:37], v3 offset:0
ds_read_b64_tr_b16 v[38:39], v3 offset:4096
v_mfma_f32_16x16x32_bf16 v[104:107], v[52:55], v[200:203], v[104:107]
ds_read_b64_tr_b16 v[40:41], v2 offset:8192
ds_read_b64_tr_b16 v[42:43], v2 offset:12288
v_mfma_f32_16x16x32_bf16 v[108:111], v[52:55], v[204:207], v[108:111]
ds_read_b64_tr_b16 v[44:45], v3 offset:8192
ds_read_b64_tr_b16 v[46:47], v3 offset:12288
s_add_u32 s46, s46, 0x1bc00
buffer_load_dwordx4 v5, s[12:15], s46 offen offset:1024 lds
ds_read_b32 v25, v6 offset:128
v_mfma_f32_16x16x32_bf16 v[112:115], v[56:59], v[200:203], v[112:115]
v_mfma_f32_16x16x32_bf16 v[116:119], v[56:59], v[204:207], v[116:119]
v_mfma_f32_16x16x32_bf16 v[120:123], v[60:63], v[200:203], v[120:123]
v_mfma_f32_16x16x32_bf16 v[124:127], v[60:63], v[204:207], v[124:127]
s_setprio 1
s_waitcnt lgkmcnt(1)
s_cmp_eq_u32 s44, 0
s_cbranch_scc0 L_if111
s_setprio 3
v_mfma_f32_16x16x1_4b_f32 v[96:111], v24, v14, v[96:111]
s_waitcnt lgkmcnt(0)
v_mfma_f32_16x16x1_4b_f32 v[112:127], v25, v14, v[112:127]
s_nop 9
v_mul_f32 v112, v96, v112
v_mul_f32 v113, v97, v113
v_mul_f32 v114, v98, v114
v_mul_f32 v115, v99, v115
v_mul_f32 v96, v10, v96
v_mul_f32 v97, v10, v97
v_mul_f32 v98, v10, v98
v_mul_f32 v99, v10, v99
v_exp_f32 v96, v96
v_exp_f32 v97, v97
v_exp_f32 v98, v98
v_exp_f32 v99, v99
v_fma_f32 v96, v96, v12, v12
v_fma_f32 v97, v97, v12, v12
v_fma_f32 v98, v98, v12, v12
v_fma_f32 v99, v99, v12, v12
v_rcp_f32 v96, v96
v_rcp_f32 v97, v97
v_rcp_f32 v98, v98
v_rcp_f32 v99, v99
v_mul_f32 v112, v112, v96
v_mul_f32 v113, v113, v97
v_mul_f32 v114, v114, v98
v_mul_f32 v115, v115, v99
v_mul_f32 v120, v104, v120
v_mul_f32 v121, v105, v121
v_mul_f32 v122, v106, v122
v_mul_f32 v123, v107, v123
v_mul_f32 v104, v10, v104
v_mul_f32 v105, v10, v105
v_mul_f32 v106, v10, v106
v_mul_f32 v107, v10, v107
v_exp_f32 v104, v104
v_exp_f32 v105, v105
v_exp_f32 v106, v106
v_exp_f32 v107, v107
v_fma_f32 v104, v104, v12, v12
v_fma_f32 v105, v105, v12, v12
v_fma_f32 v106, v106, v12, v12
v_fma_f32 v107, v107, v12, v12
v_rcp_f32 v104, v104
v_rcp_f32 v105, v105
v_rcp_f32 v106, v106
v_rcp_f32 v107, v107
v_mul_f32 v120, v120, v104
v_mul_f32 v121, v121, v105
v_mul_f32 v122, v122, v106
v_mul_f32 v123, v123, v107
v_cvt_pk_bf16_f32 v96, v112, v113
v_cvt_pk_bf16_f32 v97, v114, v115
v_cvt_pk_bf16_f32 v98, v120, v121
v_cvt_pk_bf16_f32 v99, v122, v123
s_add_u32 s58, s59, 0x0
buffer_store_dwordx4 v[96:99], v1, s[24:27], s58 offen sc1
v_mul_f32 v116, v100, v116
v_mul_f32 v117, v101, v117
v_mul_f32 v118, v102, v118
v_mul_f32 v119, v103, v119
v_mul_f32 v100, v11, v100
v_mul_f32 v101, v11, v101
v_mul_f32 v102, v11, v102
v_mul_f32 v103, v11, v103
v_exp_f32 v100, v100
v_exp_f32 v101, v101
v_exp_f32 v102, v102
v_exp_f32 v103, v103
v_fma_f32 v100, v100, v13, v13
v_fma_f32 v101, v101, v13, v13
v_fma_f32 v102, v102, v13, v13
v_fma_f32 v103, v103, v13, v13
v_rcp_f32 v100, v100
v_rcp_f32 v101, v101
v_rcp_f32 v102, v102
v_rcp_f32 v103, v103
v_mul_f32 v116, v116, v100
v_mul_f32 v117, v117, v101
v_mul_f32 v118, v118, v102
v_mul_f32 v119, v119, v103
v_mul_f32 v124, v108, v124
v_mul_f32 v125, v109, v125
v_mul_f32 v126, v110, v126
v_mul_f32 v127, v111, v127
v_mul_f32 v108, v11, v108
v_mul_f32 v109, v11, v109
v_mul_f32 v110, v11, v110
v_mul_f32 v111, v11, v111
v_exp_f32 v108, v108
v_exp_f32 v109, v109
v_exp_f32 v110, v110
v_exp_f32 v111, v111
v_fma_f32 v108, v108, v13, v13
v_fma_f32 v109, v109, v13, v13
v_fma_f32 v110, v110, v13, v13
v_fma_f32 v111, v111, v13, v13
v_rcp_f32 v108, v108
v_rcp_f32 v109, v109
v_rcp_f32 v110, v110
v_rcp_f32 v111, v111
v_mul_f32 v124, v124, v108
v_mul_f32 v125, v125, v109
v_mul_f32 v126, v126, v110
v_mul_f32 v127, v127, v111
v_cvt_pk_bf16_f32 v100, v116, v117
v_cvt_pk_bf16_f32 v101, v118, v119
v_cvt_pk_bf16_f32 v102, v124, v125
v_cvt_pk_bf16_f32 v103, v126, v127
s_add_u32 s58, s59, 0x400
buffer_store_dwordx4 v[100:103], v1, s[24:27], s58 offen sc1
v_add3_u32 v104, v96, v97, v98
v_add3_u32 v104, v104, v99, v100
v_add3_u32 v104, v104, v101, v102
v_add_u32 v104, v104, v103
v_mov_b32 v105, v104
s_nop 1
v_permlane32_swap_b32 v104, v105
v_add3_u32 v104, v104, v105, v8
s_mov_b32 exec_hi, 0
buffer_store_dword v104, v9, s[24:27], s60 offen offset:0 sc1
s_mov_b32 exec_hi, -1
s_setprio 1
L_if111:
v_mfma_f32_16x16x32_bf16 v[64:67], v[32:35], v[144:147], v[64:67]
ds_read_b64_tr_b16 v[48:49], v2 offset:1024
ds_read_b64_tr_b16 v[50:51], v2 offset:5120
v_mfma_f32_16x16x32_bf16 v[68:71], v[32:35], v[148:151], v[68:71]
ds_read_b64_tr_b16 v[52:53], v3 offset:1024
ds_read_b64_tr_b16 v[54:55], v3 offset:5120
v_mfma_f32_16x16x32_bf16 v[72:75], v[36:39], v[144:147], v[72:75]
ds_read_b64_tr_b16 v[56:57], v2 offset:9216
ds_read_b64_tr_b16 v[58:59], v2 offset:13312
v_mfma_f32_16x16x32_bf16 v[76:79], v[36:39], v[148:151], v[76:79]
ds_read_b64_tr_b16 v[60:61], v3 offset:9216
ds_read_b64_tr_b16 v[62:63], v3 offset:13312
v_mfma_f32_16x16x32_bf16 v[80:83], v[40:43], v[144:147], v[80:83]
s_add_u32 m0, s49, 0x8000
s_add_u32 s46, s55, 0x20000
buffer_load_dwordx4 v17, s[16:19], s46 offen offset:0 lds
v_mfma_f32_16x16x32_bf16 v[84:87], v[40:43], v[148:151], v[84:87]
v_mfma_f32_16x16x32_bf16 v[88:91], v[44:47], v[144:147], v[88:91]
v_mfma_f32_16x16x32_bf16 v[92:95], v[44:47], v[148:151], v[92:95]
s_setprio 1
s_waitcnt lgkmcnt(0)
v_mfma_f32_16x16x32_bf16 v[64:67], v[48:51], v[152:155], v[64:67]
v_add_u32 v2, 0xffff0000, v2
ds_read_b64_tr_b16 v[32:33], v2 offset:0
ds_read_b64_tr_b16 v[34:35], v2 offset:4096
s_add_u32 m0, s49, 0x8400
s_add_u32 s46, s55, 0x28000
buffer_load_dwordx4 v17, s[16:19], s46 offen offset:0 lds
v_mfma_f32_16x16x32_bf16 v[68:71], v[48:51], v[156:159], v[68:71]
v_add_u32 v3, 0xffff0000, v3
ds_read_b64_tr_b16 v[36:37], v3 offset:0
ds_read_b64_tr_b16 v[38:39], v3 offset:4096
v_mfma_f32_16x16x32_bf16 v[72:75], v[52:55], v[152:155], v[72:75]
ds_read_b64_tr_b16 v[40:41], v2 offset:8192
ds_read_b64_tr_b16 v[42:43], v2 offset:12288
v_mfma_f32_16x16x32_bf16 v[76:79], v[52:55], v[156:159], v[76:79]
ds_read_b64_tr_b16 v[44:45], v3 offset:8192
ds_read_b64_tr_b16 v[46:47], v3 offset:12288
s_add_u32 m0, s49, 0xc000
s_add_u32 s46, s55, 0x30000
buffer_load_dwordx4 v17, s[16:19], s46 offen offset:0 lds
v_mfma_f32_16x16x32_bf16 v[80:83], v[56:59], v[152:155], v[80:83]
v_mfma_f32_16x16x32_bf16 v[84:87], v[56:59], v[156:159], v[84:87]
v_mfma_f32_16x16x32_bf16 v[88:91], v[60:63], v[152:155], v[88:91]
v_mfma_f32_16x16x32_bf16 v[92:95], v[60:63], v[156:159], v[92:95]
s_setprio 1
s_waitcnt lgkmcnt(0)
s_add_u32 m0, s49, 0xc400
s_add_u32 s46, s55, 0x38000
buffer_load_dwordx4 v17, s[16:19], s46 offen offset:0 lds
v_mfma_f32_16x16x32_bf16 v[64:67], v[32:35], v[160:163], v[64:67]
ds_read_b64_tr_b16 v[48:49], v2 offset:1024
ds_read_b64_tr_b16 v[50:51], v2 offset:5120
v_mfma_f32_16x16x32_bf16 v[68:71], v[32:35], v[164:167], v[68:71]
ds_read_b64_tr_b16 v[52:53], v3 offset:1024
ds_read_b64_tr_b16 v[54:55], v3 offset:5120
v_mfma_f32_16x16x32_bf16 v[72:75], v[36:39], v[160:163], v[72:75]
ds_read_b64_tr_b16 v[56:57], v2 offset:9216
ds_read_b64_tr_b16 v[58:59], v2 offset:13312
v_mfma_f32_16x16x32_bf16 v[76:79], v[36:39], v[164:167], v[76:79]
ds_read_b64_tr_b16 v[60:61], v3 offset:9216
ds_read_b64_tr_b16 v[62:63], v3 offset:13312
s_add_u32 m0, s49, 0x24000
s_add_u32 s46, s55, 0x40000
buffer_load_dwordx4 v17, s[16:19], s46 offen offset:0 lds
s_cmp_eq_u32 s44, 1
s_cbranch_scc0 L_if112
s_setprio 3
v_mfma_f32_16x16x1_4b_f32 v[96:111], v24, v14, v[96:111]
v_mfma_f32_16x16x1_4b_f32 v[112:127], v25, v14, v[112:127]
s_nop 9
v_mul_f32 v112, v96, v112
v_mul_f32 v113, v97, v113
v_mul_f32 v114, v98, v114
v_mul_f32 v115, v99, v115
v_mul_f32 v96, v10, v96
v_mul_f32 v97, v10, v97
v_mul_f32 v98, v10, v98
v_mul_f32 v99, v10, v99
v_exp_f32 v96, v96
v_exp_f32 v97, v97
v_exp_f32 v98, v98
v_exp_f32 v99, v99
v_fma_f32 v96, v96, v12, v12
v_fma_f32 v97, v97, v12, v12
v_fma_f32 v98, v98, v12, v12
v_fma_f32 v99, v99, v12, v12
v_rcp_f32 v96, v96
v_rcp_f32 v97, v97
v_rcp_f32 v98, v98
v_rcp_f32 v99, v99
v_mul_f32 v112, v112, v96
v_mul_f32 v113, v113, v97
v_mul_f32 v114, v114, v98
v_mul_f32 v115, v115, v99
v_mul_f32 v120, v104, v120
v_mul_f32 v121, v105, v121
v_mul_f32 v122, v106, v122
v_mul_f32 v123, v107, v123
v_mul_f32 v104, v10, v104
v_mul_f32 v105, v10, v105
v_mul_f32 v106, v10, v106
v_mul_f32 v107, v10, v107
v_exp_f32 v104, v104
v_exp_f32 v105, v105
v_exp_f32 v106, v106
v_exp_f32 v107, v107
v_fma_f32 v104, v104, v12, v12
v_fma_f32 v105, v105, v12, v12
v_fma_f32 v106, v106, v12, v12
v_fma_f32 v107, v107, v12, v12
v_rcp_f32 v104, v104
v_rcp_f32 v105, v105
v_rcp_f32 v106, v106
v_rcp_f32 v107, v107
v_mul_f32 v120, v120, v104
v_mul_f32 v121, v121, v105
v_mul_f32 v122, v122, v106
v_mul_f32 v123, v123, v107
v_cvt_pk_bf16_f32 v96, v112, v113
v_cvt_pk_bf16_f32 v97, v114, v115
v_cvt_pk_bf16_f32 v98, v120, v121
v_cvt_pk_bf16_f32 v99, v122, v123
s_add_u32 s58, s59, 0x0
buffer_store_dwordx4 v[96:99], v1, s[24:27], s58 offen sc1
v_mul_f32 v116, v100, v116
v_mul_f32 v117, v101, v117
v_mul_f32 v118, v102, v118
v_mul_f32 v119, v103, v119
v_mul_f32 v100, v11, v100
v_mul_f32 v101, v11, v101
v_mul_f32 v102, v11, v102
v_mul_f32 v103, v11, v103
v_exp_f32 v100, v100
v_exp_f32 v101, v101
v_exp_f32 v102, v102
v_exp_f32 v103, v103
v_fma_f32 v100, v100, v13, v13
v_fma_f32 v101, v101, v13, v13
v_fma_f32 v102, v102, v13, v13
v_fma_f32 v103, v103, v13, v13
v_rcp_f32 v100, v100
v_rcp_f32 v101, v101
v_rcp_f32 v102, v102
v_rcp_f32 v103, v103
v_mul_f32 v116, v116, v100
v_mul_f32 v117, v117, v101
v_mul_f32 v118, v118, v102
v_mul_f32 v119, v119, v103
v_mul_f32 v124, v108, v124
v_mul_f32 v125, v109, v125
v_mul_f32 v126, v110, v126
v_mul_f32 v127, v111, v127
v_mul_f32 v108, v11, v108
v_mul_f32 v109, v11, v109
v_mul_f32 v110, v11, v110
v_mul_f32 v111, v11, v111
v_exp_f32 v108, v108
v_exp_f32 v109, v109
v_exp_f32 v110, v110
v_exp_f32 v111, v111
v_fma_f32 v108, v108, v13, v13
v_fma_f32 v109, v109, v13, v13
v_fma_f32 v110, v110, v13, v13
v_fma_f32 v111, v111, v13, v13
v_rcp_f32 v108, v108
v_rcp_f32 v109, v109
v_rcp_f32 v110, v110
v_rcp_f32 v111, v111
v_mul_f32 v124, v124, v108
v_mul_f32 v125, v125, v109
v_mul_f32 v126, v126, v110
v_mul_f32 v127, v127, v111
v_cvt_pk_bf16_f32 v100, v116, v117
v_cvt_pk_bf16_f32 v101, v118, v119
v_cvt_pk_bf16_f32 v102, v124, v125
v_cvt_pk_bf16_f32 v103, v126, v127
s_add_u32 s58, s59, 0x400
buffer_store_dwordx4 v[100:103], v1, s[24:27], s58 offen sc1
v_add3_u32 v104, v96, v97, v98
v_add3_u32 v104, v104, v99, v100
v_add3_u32 v104, v104, v101, v102
v_add_u32 v104, v104, v103
v_mov_b32 v105, v104
s_nop 1
v_permlane32_swap_b32 v104, v105
v_add3_u32 v104, v104, v105, v8
s_mov_b32 exec_hi, 0
buffer_store_dword v104, v9, s[24:27], s60 offen offset:0 sc1
s_mov_b32 exec_hi, -1
s_setprio 1
L_if112:
v_mfma_f32_16x16x32_bf16 v[80:83], v[40:43], v[160:163], v[80:83]
v_mfma_f32_16x16x32_bf16 v[84:87], v[40:43], v[164:167], v[84:87]
v_mfma_f32_16x16x32_bf16 v[88:91], v[44:47], v[160:163], v[88:91]
v_mfma_f32_16x16x32_bf16 v[92:95], v[44:47], v[164:167], v[92:95]
s_waitcnt vmcnt(9) lgkmcnt(0)
s_barrier
s_setprio 3
v_mfma_f32_16x16x32_bf16 v[64:67], v[48:51], v[168:171], v[64:67]
v_add_u32 v2, 0x10000, v2
ds_read_b64_tr_b16 v[32:33], v2 offset:16384
ds_read_b64_tr_b16 v[34:35], v2 offset:20480
s_add_u32 m0, s49, 0x24400
s_add_u32 s46, s55, 0x48000
buffer_load_dwordx4 v17, s[16:19], s46 offen offset:0 lds
v_mfma_f32_16x16x32_bf16 v[68:71], v[48:51], v[172:175], v[68:71]
v_add_u32 v3, 0x10000, v3
ds_read_b64_tr_b16 v[36:37], v3 offset:16384
ds_read_b64_tr_b16 v[38:39], v3 offset:20480
v_mfma_f32_16x16x32_bf16 v[72:75], v[52:55], v[168:171], v[72:75]
ds_read_b64_tr_b16 v[40:41], v2 offset:24576
ds_read_b64_tr_b16 v[42:43], v2 offset:28672
s_add_u32 m0, s49, 0x0
s_add_u32 s46, s55, 0x50000
buffer_load_dwordx4 v17, s[16:19], s46 offen offset:0 lds
v_mfma_f32_16x16x32_bf16 v[76:79], v[52:55], v[172:175], v[76:79]
ds_read_b64_tr_b16 v[44:45], v3 offset:24576
ds_read_b64_tr_b16 v[46:47], v3 offset:28672
v_mfma_f32_16x16x32_bf16 v[80:83], v[56:59], v[168:171], v[80:83]
v_mfma_f32_16x16x32_bf16 v[84:87], v[56:59], v[172:175], v[84:87]
s_add_u32 m0, s49, 0x400
s_add_u32 s46, s55, 0x58000
buffer_load_dwordx4 v17, s[16:19], s46 offen offset:0 lds
v_mfma_f32_16x16x32_bf16 v[88:91], v[60:63], v[168:171], v[88:91]
v_mfma_f32_16x16x32_bf16 v[92:95], v[60:63], v[172:175], v[92:95]
s_setprio 2
s_waitcnt lgkmcnt(0)
v_mfma_f32_16x16x32_bf16 v[64:67], v[32:35], v[176:179], v[64:67]
ds_read_b64_tr_b16 v[48:49], v2 offset:17408
ds_read_b64_tr_b16 v[50:51], v2 offset:21504
v_mfma_f32_16x16x32_bf16 v[68:71], v[32:35], v[180:183], v[68:71]
ds_read_b64_tr_b16 v[52:53], v3 offset:17408
ds_read_b64_tr_b16 v[54:55], v3 offset:21504
s_add_u32 m0, s49, 0x10000
s_add_u32 s46, s55, 0x0
buffer_load_dwordx4 v17, s[16:19], s46 offen offset:0 lds
v_mfma_f32_16x16x32_bf16 v[72:75], v[36:39], v[176:179], v[72:75]
ds_read_b64_tr_b16 v[56:57], v2 offset:25600
ds_read_b64_tr_b16 v[58:59], v2 offset:29696
v_mfma_f32_16x16x32_bf16 v[76:79], v[36:39], v[180:183], v[76:79]
ds_read_b64_tr_b16 v[60:61], v3 offset:25600
ds_read_b64_tr_b16 v[62:63], v3 offset:29696
v_mfma_f32_16x16x32_bf16 v[80:83], v[40:43], v[176:179], v[80:83]
v_mfma_f32_16x16x32_bf16 v[84:87], v[40:43], v[180:183], v[84:87]
s_add_u32 m0, s49, 0x10400
s_add_u32 s46, s55, 0x8000
buffer_load_dwordx4 v17, s[16:19], s46 offen offset:0 lds
v_mfma_f32_16x16x32_bf16 v[88:91], v[44:47], v[176:179], v[88:91]
v_mfma_f32_16x16x32_bf16 v[92:95], v[44:47], v[180:183], v[92:95]
s_setprio 1
s_waitcnt lgkmcnt(0)
v_mfma_f32_16x16x32_bf16 v[64:67], v[48:51], v[184:187], v[64:67]
ds_read_b64_tr_b16 v[32:33], v2 offset:32768
ds_read_b64_tr_b16 v[34:35], v2 offset:36864
v_mfma_f32_16x16x32_bf16 v[68:71], v[48:51], v[188:191], v[68:71]
ds_read_b64_tr_b16 v[36:37], v3 offset:32768
ds_read_b64_tr_b16 v[38:39], v3 offset:36864
v_mfma_f32_16x16x32_bf16 v[72:75], v[52:55], v[184:187], v[72:75]
ds_read_b64_tr_b16 v[40:41], v2 offset:40960
ds_read_b64_tr_b16 v[42:43], v2 offset:45056
v_mfma_f32_16x16x32_bf16 v[76:79], v[52:55], v[188:191], v[76:79]
ds_read_b64_tr_b16 v[44:45], v3 offset:40960
ds_read_b64_tr_b16 v[46:47], v3 offset:45056
v_mfma_f32_16x16x32_bf16 v[80:83], v[56:59], v[184:187], v[80:83]
v_mfma_f32_16x16x32_bf16 v[84:87], v[56:59], v[188:191], v[84:87]
v_mfma_f32_16x16x32_bf16 v[88:91], v[60:63], v[184:187], v[88:91]
v_mfma_f32_16x16x32_bf16 v[92:95], v[60:63], v[188:191], v[92:95]
s_setprio 0
s_waitcnt lgkmcnt(0)
v_mfma_f32_16x16x32_bf16 v[64:67], v[32:35], v[192:195], v[64:67]
ds_read_b64_tr_b16 v[48:49], v2 offset:33792
ds_read_b64_tr_b16 v[50:51], v2 offset:37888
v_mfma_f32_16x16x32_bf16 v[68:71], v[32:35], v[196:199], v[68:71]
ds_read_b64_tr_b16 v[52:53], v3 offset:33792
ds_read_b64_tr_b16 v[54:55], v3 offset:37888
v_mfma_f32_16x16x32_bf16 v[72:75], v[36:39], v[192:195], v[72:75]
ds_read_b64_tr_b16 v[56:57], v2 offset:41984
ds_read_b64_tr_b16 v[58:59], v2 offset:46080
v_mfma_f32_16x16x32_bf16 v[76:79], v[36:39], v[196:199], v[76:79]
ds_read_b64_tr_b16 v[60:61], v3 offset:41984
ds_read_b64_tr_b16 v[62:63], v3 offset:46080
v_mfma_f32_16x16x32_bf16 v[80:83], v[40:43], v[192:195], v[80:83]
v_mfma_f32_16x16x32_bf16 v[84:87], v[40:43], v[196:199], v[84:87]
v_mfma_f32_16x16x32_bf16 v[88:91], v[44:47], v[192:195], v[88:91]
v_mfma_f32_16x16x32_bf16 v[92:95], v[44:47], v[196:199], v[92:95]
s_waitcnt vmcnt(12) lgkmcnt(0)
s_barrier
s_setprio 1
v_mfma_f32_16x16x32_bf16 v[64:67], v[48:51], v[200:203], v[64:67]
v_add_u32 v7, 0x10000, v7
ds_read_b64_tr_b16 v[32:33], v7 offset:49152
ds_read_b64_tr_b16 v[34:35], v7 offset:51200
s_add_u32 m0, s49, 0x14000
s_add_u32 s46, s55, 0x10000
buffer_load_dwordx4 v17, s[16:19], s46 offen offset:0 lds
v_mfma_f32_16x16x32_bf16 v[68:71], v[48:51], v[204:207], v[68:71]
ds_read_b64_tr_b16 v[36:37], v7 offset:57344
ds_read_b64_tr_b16 v[38:39], v7 offset:59392
s_add_u32 m0, s49, 0x14400
s_add_u32 s46, s55, 0x18000
buffer_load_dwordx4 v17, s[16:19], s46 offen offset:0 lds
ds_read_b32 v24, v6 offset:256
v_mfma_f32_16x16x32_bf16 v[72:75], v[52:55], v[200:203], v[72:75]
ds_read_b64_tr_b16 v[40:41], v7 offset:50176
ds_read_b64_tr_b16 v[42:43], v7 offset:52224
s_add_u32 s58, s90, 0
buffer_load_dwordx4 v[208:211], v1, s[24:27], s58 offen sc1
v_mfma_f32_16x16x32_bf16 v[76:79], v[52:55], v[204:207], v[76:79]
ds_read_b64_tr_b16 v[44:45], v7 offset:58368
ds_read_b64_tr_b16 v[46:47], v7 offset:60416
ds_read_b32 v25, v6 offset:384
v_mfma_f32_16x16x32_bf16 v[80:83], v[56:59], v[200:203], v[80:83]
v_mfma_f32_16x16x32_bf16 v[84:87], v[56:59], v[204:207], v[84:87]
v_mfma_f32_16x16x32_bf16 v[88:91], v[60:63], v[200:203], v[88:91]
s_add_u32 s58, s90, 1024
buffer_load_dwordx4 v[212:215], v1, s[24:27], s58 offen sc1
v_mfma_f32_16x16x32_bf16 v[92:95], v[60:63], v[204:207], v[92:95]
s_setprio 0
s_waitcnt lgkmcnt(1)
v_mfma_f32_16x16x1_4b_f32 v[64:79], v24, v14, v[64:79]
s_waitcnt lgkmcnt(0)
s_nop 1
v_mfma_f32_16x16x1_4b_f32 v[80:95], v25, v14, v[80:95]
s_nop 9
v_mul_f32 v80, v64, v80
v_mul_f32 v81, v65, v81
v_mul_f32 v82, v66, v82
v_mul_f32 v83, v67, v83
v_mul_f32 v64, v10, v64
v_mul_f32 v65, v10, v65
v_mul_f32 v66, v10, v66
v_mul_f32 v67, v10, v67
v_exp_f32 v64, v64
v_exp_f32 v65, v65
v_exp_f32 v66, v66
v_exp_f32 v67, v67
v_fma_f32 v64, v64, v12, v12
v_fma_f32 v65, v65, v12, v12
v_fma_f32 v66, v66, v12, v12
v_fma_f32 v67, v67, v12, v12
v_rcp_f32 v64, v64
v_rcp_f32 v65, v65
v_rcp_f32 v66, v66
v_rcp_f32 v67, v67
v_mfma_f32_16x16x32_bf16 v[128:131], v[32:35], v[144:147], v[128:131]
ds_read_b64_tr_b16 v[48:49], v7 offset:53248
ds_read_b64_tr_b16 v[50:51], v7 offset:55296
s_add_u32 s58, s90, 2048
buffer_load_dwordx4 v[216:219], v1, s[24:27], s58 offen sc1
s_add_u32 s58, s90, 3072
buffer_load_dwordx4 v[220:223], v1, s[24:27], s58 offen sc1
buffer_load_dword v18, v9, s[24:27], s92 offen offset:0 sc1
s_add_u32 s58, s90, 4096
buffer_load_dwordx4 v[224:227], v1, s[24:27], s58 offen sc1
v_mul_f32 v80, v80, v64
v_mul_f32 v81, v81, v65
v_mul_f32 v82, v82, v66
v_mul_f32 v83, v83, v67
v_mul_f32 v88, v72, v88
v_mul_f32 v89, v73, v89
v_mul_f32 v90, v74, v90
v_mul_f32 v91, v75, v91
v_mul_f32 v72, v10, v72
v_mul_f32 v73, v10, v73
v_mul_f32 v74, v10, v74
v_mul_f32 v75, v10, v75
v_exp_f32 v72, v72
v_exp_f32 v73, v73
v_exp_f32 v74, v74
v_exp_f32 v75, v75
v_fma_f32 v72, v72, v12, v12
v_fma_f32 v73, v73, v12, v12
v_fma_f32 v74, v74, v12, v12
v_fma_f32 v75, v75, v12, v12
v_rcp_f32 v72, v72
v_rcp_f32 v73, v73
v_rcp_f32 v74, v74
v_rcp_f32 v75, v75
v_mfma_f32_16x16x32_bf16 v[132:135], v[32:35], v[148:151], v[132:135]
ds_read_b64_tr_b16 v[52:53], v7 offset:61440
ds_read_b64_tr_b16 v[54:55], v7 offset:63488
s_add_u32 s58, s90, 5120
buffer_load_dwordx4 v[228:231], v1, s[24:27], s58 offen sc1
v_mul_f32 v88, v88, v72
v_mul_f32 v89, v89, v73
v_mul_f32 v90, v90, v74
v_mul_f32 v91, v91, v75
v_cvt_pk_bf16_f32 v64, v80, v81
v_cvt_pk_bf16_f32 v65, v82, v83
v_cvt_pk_bf16_f32 v66, v88, v89
v_cvt_pk_bf16_f32 v67, v90, v91
s_add_u32 s58, s59, 0x2000
buffer_store_dwordx4 v[64:67], v1, s[24:27], s58 offen sc1
v_mul_f32 v84, v68, v84
v_mul_f32 v85, v69, v85
v_mul_f32 v86, v70, v86
v_mul_f32 v87, v71, v87
v_mul_f32 v68, v11, v68
v_mul_f32 v69, v11, v69
v_mul_f32 v70, v11, v70
v_mul_f32 v71, v11, v71
v_exp_f32 v68, v68
v_exp_f32 v69, v69
v_exp_f32 v70, v70
v_exp_f32 v71, v71
v_fma_f32 v68, v68, v13, v13
v_fma_f32 v69, v69, v13, v13
v_mfma_f32_16x16x32_bf16 v[136:139], v[36:39], v[144:147], v[136:139]
ds_read_b64_tr_b16 v[56:57], v7 offset:54272
ds_read_b64_tr_b16 v[58:59], v7 offset:56320
v_fma_f32 v70, v70, v13, v13
v_fma_f32 v71, v71, v13, v13
v_rcp_f32 v68, v68
v_rcp_f32 v69, v69
v_rcp_f32 v70, v70
v_rcp_f32 v71, v71
v_mul_f32 v84, v84, v68
v_mul_f32 v85, v85, v69
v_mul_f32 v86, v86, v70
v_mul_f32 v87, v87, v71
v_mul_f32 v92, v76, v92
v_mul_f32 v93, v77, v93
v_mul_f32 v94, v78, v94
v_mul_f32 v95, v79, v95
v_mul_f32 v76, v11, v76
v_mul_f32 v77, v11, v77
v_mul_f32 v78, v11, v78
v_mul_f32 v79, v11, v79
v_exp_f32 v76, v76
v_exp_f32 v77, v77
v_exp_f32 v78, v78
v_exp_f32 v79, v79
v_fma_f32 v76, v76, v13, v13
v_fma_f32 v77, v77, v13, v13
v_mfma_f32_16x16x32_bf16 v[140:143], v[36:39], v[148:151], v[140:143]
ds_read_b64_tr_b16 v[60:61], v7 offset:62464
ds_read_b64_tr_b16 v[62:63], v7 offset:64512
s_add_u32 s58, s90, 6144
buffer_load_dwordx4 v[232:235], v1, s[24:27], s58 offen sc1
v_fma_f32 v78, v78, v13, v13
v_fma_f32 v79, v79, v13, v13
v_rcp_f32 v76, v76
v_rcp_f32 v77, v77
v_rcp_f32 v78, v78
v_rcp_f32 v79, v79
v_mul_f32 v92, v92, v76
v_mul_f32 v93, v93, v77
v_mul_f32 v94, v94, v78
v_mul_f32 v95, v95, v79
v_cvt_pk_bf16_f32 v68, v84, v85
v_cvt_pk_bf16_f32 v69, v86, v87
v_cvt_pk_bf16_f32 v70, v92, v93
v_cvt_pk_bf16_f32 v71, v94, v95
s_add_u32 s58, s59, 0x2400
buffer_store_dwordx4 v[68:71], v1, s[24:27], s58 offen sc1
v_add3_u32 v72, v64, v65, v66
v_add3_u32 v72, v72, v67, v68
v_add3_u32 v72, v72, v69, v70
v_add_u32 v72, v72, v71
v_mov_b32 v73, v72
s_nop 1
v_permlane32_swap_b32 v72, v73
v_add3_u32 v72, v72, v73, v8
s_mov_b32 exec_hi, 0
buffer_store_dword v72, v9, s[24:27], s60 offen offset:512 sc1
s_mov_b32 exec_hi, -1
v_mfma_f32_16x16x32_bf16 v[128:131], v[40:43], v[152:155], v[128:131]
v_mfma_f32_16x16x32_bf16 v[132:135], v[40:43], v[156:159], v[132:135]
v_mfma_f32_16x16x32_bf16 v[136:139], v[44:47], v[152:155], v[136:139]
v_mfma_f32_16x16x32_bf16 v[140:143], v[44:47], v[156:159], v[140:143]
s_waitcnt vmcnt(23) lgkmcnt(0)
s_barrier
s_setprio 1
v_mfma_f32_16x16x32_bf16 v[128:131], v[48:51], v[160:163], v[128:131]
v_add_u32 v7, 0xffff0000, v7
ds_read_b64_tr_b16 v[32:33], v7 offset:16384
ds_read_b64_tr_b16 v[34:35], v7 offset:18432
s_add_u32 s58, s90, 7168
buffer_load_dwordx4 v[236:239], v1, s[24:27], s58 offen sc1
buffer_load_dword v19, v9, s[24:27], s92 offen offset:256 sc1
v_mfma_f32_16x16x32_bf16 v[132:135], v[48:51], v[164:167], v[132:135]
ds_read_b64_tr_b16 v[36:37], v7 offset:24576
ds_read_b64_tr_b16 v[38:39], v7 offset:26624
v_mfma_f32_16x16x32_bf16 v[136:139], v[52:55], v[160:163], v[136:139]
ds_read_b64_tr_b16 v[40:41], v7 offset:17408
ds_read_b64_tr_b16 v[42:43], v7 offset:19456
v_mfma_f32_16x16x32_bf16 v[140:143], v[52:55], v[164:167], v[140:143]
ds_read_b64_tr_b16 v[44:45], v7 offset:25600
ds_read_b64_tr_b16 v[46:47], v7 offset:27648
v_mfma_f32_16x16x32_bf16 v[128:131], v[56:59], v[168:171], v[128:131]
v_mfma_f32_16x16x32_bf16 v[132:135], v[56:59], v[172:175], v[132:135]
v_mfma_f32_16x16x32_bf16 v[136:139], v[60:63], v[168:171], v[136:139]
v_mfma_f32_16x16x32_bf16 v[140:143], v[60:63], v[172:175], v[140:143]
s_setprio 0
s_waitcnt lgkmcnt(0)
v_mfma_f32_16x16x32_bf16 v[128:131], v[32:35], v[176:179], v[128:131]
ds_read_b64_tr_b16 v[48:49], v7 offset:20480
ds_read_b64_tr_b16 v[50:51], v7 offset:22528
v_mfma_f32_16x16x32_bf16 v[132:135], v[32:35], v[180:183], v[132:135]
ds_read_b64_tr_b16 v[52:53], v7 offset:28672
ds_read_b64_tr_b16 v[54:55], v7 offset:30720
v_mfma_f32_16x16x32_bf16 v[136:139], v[36:39], v[176:179], v[136:139]
ds_read_b64_tr_b16 v[56:57], v7 offset:21504
ds_read_b64_tr_b16 v[58:59], v7 offset:23552
s_add_u32 m0, s49, 0x18000
s_add_u32 s46, s55, 0x60000
buffer_load_dwordx4 v17, s[16:19], s46 offen offset:0 lds
v_mfma_f32_16x16x32_bf16 v[140:143], v[36:39], v[180:183], v[140:143]
ds_read_b64_tr_b16 v[60:61], v7 offset:29696
ds_read_b64_tr_b16 v[62:63], v7 offset:31744
v_mfma_f32_16x16x32_bf16 v[128:131], v[40:43], v[184:187], v[128:131]
v_mfma_f32_16x16x32_bf16 v[132:135], v[40:43], v[188:191], v[132:135]
s_waitcnt vmcnt(9)
v_add3_u32 v22, v208, v209, v210
v_add3_u32 v22, v22, v211, v212
v_add3_u32 v22, v22, v213, v214
v_add_u32 v22, v22, v215
v_add3_u32 v23, v216, v217, v218
v_add3_u32 v23, v23, v219, v220
v_add3_u32 v23, v23, v221, v222
v_add_u32 v23, v23, v223
s_nop 1
v_permlane32_swap_b32 v22, v23
v_add3_u32 v22, v22, v23, v8
v_cmp_ne_u32 vcc, v22, v18
s_cbranch_vccnz L_slow87
L_back88:
v_mfma_f32_16x16x32_bf16 v[136:139], v[44:47], v[184:187], v[136:139]
s_add_u32 m0, s49, 0x18400
s_add_u32 s46, s55, 0x68000
buffer_load_dwordx4 v17, s[16:19], s46 offen offset:0 lds
v_mfma_f32_16x16x32_bf16 v[140:143], v[44:47], v[188:191], v[140:143]
s_add_u32 m0, s49, 0x1c000
s_add_u32 s46, s56, 0x0
buffer_load_dwordx4 v17, s[20:23], s46 offen offset:0 lds
s_waitcnt vmcnt(3)
v_add3_u32 v22, v224, v225, v226
v_add3_u32 v22, v22, v227, v228
v_add3_u32 v22, v22, v229, v230
v_add_u32 v22, v22, v231
v_add3_u32 v23, v232, v233, v234
v_add3_u32 v23, v23, v235, v236
v_add3_u32 v23, v23, v237, v238
v_add_u32 v23, v23, v239
s_nop 1
v_permlane32_swap_b32 v22, v23
v_add3_u32 v22, v22, v23, v8
v_cmp_ne_u32 vcc, v22, v19
s_cbranch_vccnz L_slow90
L_back91:
s_waitcnt lgkmcnt(0)
s_barrier
s_setprio 3
v_mfma_f32_16x16x32_bf16 v[128:131], v[48:51], v[192:195], v[128:131]
s_xor_b32 s58, s3, s44
s_lshl_b32 s58, s58, 6
v_and_b32 v2, 0xffff, v2
v_xor_b32 v2, s58, v2
s_lshl_b32 s58, s44, 13
s_add_u32 s58, s58, 0x0
v_add_u32 v2, s58, v2
v_xor_b32 v3, 32, v2
v_xor_b32 v18, 64, v2
v_xor_b32 v19, 0x60, v2
ds_read_b64_tr_b16 v[32:33], v2 offset:32768
s_add_u32 m0, s49, 0x1c400
s_add_u32 s46, s56, 0x8000
buffer_load_dwordx4 v17, s[20:23], s46 offen offset:0 lds
v_mfma_f32_16x16x32_bf16 v[132:135], v[48:51], v[196:199], v[132:135]
ds_read_b64_tr_b16 v[34:35], v2 offset:36864
ds_read_b64_tr_b16 v[36:37], v3 offset:32768
s_add_u32 m0, s49, 0x4000
s_add_u32 s46, s56, 0x10000
buffer_load_dwordx4 v17, s[20:23], s46 offen offset:0 lds
ds_read_b32 v24, v6 offset:512
v_mfma_f32_16x16x32_bf16 v[136:139], v[52:55], v[192:195], v[136:139]
ds_read_b64_tr_b16 v[38:39], v3 offset:36864
ds_read_b64_tr_b16 v[40:41], v18 offset:32768
v_mfma_f32_16x16x32_bf16 v[140:143], v[52:55], v[196:199], v[140:143]
ds_read_b64_tr_b16 v[42:43], v18 offset:36864
ds_read_b64_tr_b16 v[44:45], v19 offset:32768
v_mfma_f32_16x16x32_bf16 v[128:131], v[56:59], v[200:203], v[128:131]
ds_read_b64_tr_b16 v[46:47], v19 offset:36864
v_mfma_f32_16x16x32_bf16 v[132:135], v[56:59], v[204:207], v[132:135]
s_add_u32 m0, s49, 0x4400
s_add_u32 s46, s56, 0x18000
buffer_load_dwordx4 v17, s[20:23], s46 offen offset:0 lds
v_mfma_f32_16x16x32_bf16 v[136:139], v[60:63], v[200:203], v[136:139]
v_mfma_f32_16x16x32_bf16 v[140:143], v[60:63], v[204:207], v[140:143]
s_setprio 2
s_waitcnt lgkmcnt(0)
s_nop 3
v_mfma_f32_16x16x1_4b_f32 v[128:143], v24, v14, v[128:143]
s_nop 9
v_mul_f32 v136, v128, v136
v_mul_f32 v137, v129, v137
v_mul_f32 v138, v130, v138
v_mul_f32 v139, v131, v139
v_mul_f32 v128, v10, v128
v_mul_f32 v129, v10, v129
v_mul_f32 v130, v10, v130
v_mul_f32 v131, v10, v131
v_exp_f32 v128, v128
v_exp_f32 v129, v129
v_exp_f32 v130, v130
v_exp_f32 v131, v131
v_fma_f32 v128, v128, v12, v12
v_fma_f32 v129, v129, v12, v12
v_fma_f32 v130, v130, v12, v12
v_fma_f32 v131, v131, v12, v12
v_rcp_f32 v128, v128
v_rcp_f32 v129, v129
v_rcp_f32 v130, v130
v_rcp_f32 v131, v131
v_mul_f32 v136, v136, v128
v_mul_f32 v137, v137, v129
v_mul_f32 v138, v138, v130
v_mul_f32 v139, v139, v131
v_cvt_pk_bf16_f32 v240, v136, v137
v_cvt_pk_bf16_f32 v241, v138, v139
v_mul_f32 v140, v132, v140
v_mul_f32 v141, v133, v141
v_mul_f32 v142, v134, v142
v_mul_f32 v143, v135, v143
v_mul_f32 v132, v11, v132
v_mul_f32 v133, v11, v133
v_mul_f32 v134, v11, v134
v_mul_f32 v135, v11, v135
v_exp_f32 v132, v132
v_exp_f32 v133, v133
v_exp_f32 v134, v134
v_exp_f32 v135, v135
v_fma_f32 v132, v132, v13, v13
v_fma_f32 v133, v133, v13, v13
v_fma_f32 v134, v134, v13, v13
v_fma_f32 v135, v135, v13, v13
v_rcp_f32 v132, v132
v_rcp_f32 v133, v133
v_rcp_f32 v134, v134
v_rcp_f32 v135, v135
v_mul_f32 v140, v140, v132
v_mul_f32 v141, v141, v133
v_mul_f32 v142, v142, v134
v_mul_f32 v143, v143, v135
v_cvt_pk_bf16_f32 v242, v140, v141
v_cvt_pk_bf16_f32 v243, v142, v143
s_add_u32 s58, s86, 24576
buffer_store_dwordx4 v[240:243], v1, s[24:27], s58 offen sc1
v_add3_u32 v128, v240, v241, v242
v_add_u32 v128, v128, v243
v_mov_b32 v129, v128
s_nop 1
v_permlane32_swap_b32 v128, v129
v_add3_u32 v128, v128, v129, v8
s_mov_b32 exec_hi, 0
buffer_store_dword v128, v9, s[24:27], s60 offen offset:1536 sc1
s_mov_b32 exec_hi, -1
v_mfma_f32_16x16x32_bf16 v[96:99], v[32:35], v[208:211], 0
ds_read_b64_tr_b16 v[48:49], v2 offset:33792
ds_read_b64_tr_b16 v[50:51], v2 offset:37888
v_mfma_f32_16x16x32_bf16 v[100:103], v[32:35], v[212:215], 0
ds_read_b64_tr_b16 v[52:53], v3 offset:33792
ds_read_b64_tr_b16 v[54:55], v3 offset:37888
v_mfma_f32_16x16x32_bf16 v[104:107], v[36:39], v[208:211], 0
ds_read_b64_tr_b16 v[56:57], v18 offset:33792
ds_read_b64_tr_b16 v[58:59], v18 offset:37888
v_mfma_f32_16x16x32_bf16 v[108:111], v[36:39], v[212:215], 0
ds_read_b64_tr_b16 v[60:61], v19 offset:33792
ds_read_b64_tr_b16 v[62:63], v19 offset:37888
v_mfma_f32_16x16x32_bf16 v[112:115], v[40:43], v[208:211], 0
s_add_u32 s58, s90, 8192
buffer_load_dwordx4 v[144:147], v1, s[24:27], s58 offen sc1
v_mfma_f32_16x16x32_bf16 v[116:119], v[40:43], v[212:215], 0
s_add_u32 s58, s90, 9216
buffer_load_dwordx4 v[148:151], v1, s[24:27], s58 offen sc1
v_mfma_f32_16x16x32_bf16 v[120:123], v[44:47], v[208:211], 0
v_mfma_f32_16x16x32_bf16 v[124:127], v[44:47], v[212:215], 0
s_setprio 1
s_waitcnt lgkmcnt(0)
s_add_u32 s58, s90, 10240
buffer_load_dwordx4 v[152:155], v1, s[24:27], s58 offen sc1
v_mfma_f32_16x16x32_bf16 v[96:99], v[48:51], v[216:219], v[96:99]
ds_read_b64_tr_b16 v[32:33], v2 offset:49152
ds_read_b64_tr_b16 v[34:35], v2 offset:53248
v_mfma_f32_16x16x32_bf16 v[100:103], v[48:51], v[220:223], v[100:103]
ds_read_b64_tr_b16 v[36:37], v3 offset:49152
ds_read_b64_tr_b16 v[38:39], v3 offset:53248
v_mfma_f32_16x16x32_bf16 v[104:107], v[52:55], v[216:219], v[104:107]
ds_read_b64_tr_b16 v[40:41], v18 offset:49152
ds_read_b64_tr_b16 v[42:43], v18 offset:53248
v_mfma_f32_16x16x32_bf16 v[108:111], v[52:55], v[220:223], v[108:111]
ds_read_b64_tr_b16 v[44:45], v19 offset:49152
ds_read_b64_tr_b16 v[46:47], v19 offset:53248
s_add_u32 s58, s90, 11264
buffer_load_dwordx4 v[156:159], v1, s[24:27], s58 offen sc1
buffer_load_dword v244, v9, s[24:27], s92 offen offset:512 sc1
v_mfma_f32_16x16x32_bf16 v[112:115], v[56:59], v[216:219], v[112:115]
v_mfma_f32_16x16x32_bf16 v[116:119], v[56:59], v[220:223], v[116:119]
v_mfma_f32_16x16x32_bf16 v[120:123], v[60:63], v[216:219], v[120:123]
v_mfma_f32_16x16x32_bf16 v[124:127], v[60:63], v[220:223], v[124:127]
s_setprio 0
s_waitcnt lgkmcnt(0)
v_mfma_f32_16x16x32_bf16 v[96:99], v[32:35], v[224:227], v[96:99]
ds_read_b64_tr_b16 v[48:49], v2 offset:50176
ds_read_b64_tr_b16 v[50:51], v2 offset:54272
s_add_u32 s58, s90, 12288
buffer_load_dwordx4 v[160:163], v1, s[24:27], s58 offen sc1
v_mfma_f32_16x16x32_bf16 v[100:103], v[32:35], v[228:231], v[100:103]
ds_read_b64_tr_b16 v[52:53], v3 offset:50176
ds_read_b64_tr_b16 v[54:55], v3 offset:54272
v_mfma_f32_16x16x32_bf16 v[104:107], v[36:39], v[224:227], v[104:107]
ds_read_b64_tr_b16 v[56:57], v18 offset:50176
ds_read_b64_tr_b16 v[58:59], v18 offset:54272
v_mfma_f32_16x16x32_bf16 v[108:111], v[36:39], v[228:231], v[108:111]
ds_read_b64_tr_b16 v[60:61], v19 offset:50176
ds_read_b64_tr_b16 v[62:63], v19 offset:54272
v_mfma_f32_16x16x32_bf16 v[112:115], v[40:43], v[224:227], v[112:115]
s_add_u32 s58, s90, 13312
buffer_load_dwordx4 v[164:167], v1, s[24:27], s58 offen sc1
v_mfma_f32_16x16x32_bf16 v[116:119], v[40:43], v[228:231], v[116:119]
v_mfma_f32_16x16x32_bf16 v[120:123], v[44:47], v[224:227], v[120:123]
v_mfma_f32_16x16x32_bf16 v[124:127], v[44:47], v[228:231], v[124:127]
s_waitcnt lgkmcnt(0)
s_barrier
s_setprio 3
v_mfma_f32_16x16x32_bf16 v[96:99], v[48:51], v[232:235], v[96:99]
v_add_u32 v2, 0x20000, v2
ds_read_b64_tr_b16 v[32:33], v2 offset:16384
ds_read_b64_tr_b16 v[34:35], v2 offset:20480
s_add_u32 s58, s90, 14336
buffer_load_dwordx4 v[168:171], v1, s[24:27], s58 offen sc1
v_mfma_f32_16x16x32_bf16 v[100:103], v[48:51], v[236:239], v[100:103]
v_add_u32 v3, 0x20000, v3
ds_read_b64_tr_b16 v[36:37], v3 offset:16384
ds_read_b64_tr_b16 v[38:39], v3 offset:20480
v_mfma_f32_16x16x32_bf16 v[104:107], v[52:55], v[232:235], v[104:107]
v_add_u32 v18, 0x20000, v18
ds_read_b64_tr_b16 v[40:41], v18 offset:16384
ds_read_b64_tr_b16 v[42:43], v18 offset:20480
s_add_u32 s58, s90, 15360
buffer_load_dwordx4 v[172:175], v1, s[24:27], s58 offen sc1
buffer_load_dword v245, v9, s[24:27], s92 offen offset:768 sc1
v_mfma_f32_16x16x32_bf16 v[108:111], v[52:55], v[236:239], v[108:111]
v_add_u32 v19, 0x20000, v19
ds_read_b64_tr_b16 v[44:45], v19 offset:16384
ds_read_b64_tr_b16 v[46:47], v19 offset:20480
v_mfma_f32_16x16x32_bf16 v[112:115], v[56:59], v[232:235], v[112:115]
v_mfma_f32_16x16x32_bf16 v[116:119], v[56:59], v[236:239], v[116:119]
v_mfma_f32_16x16x32_bf16 v[120:123], v[60:63], v[232:235], v[120:123]
s_add_u32 s58, s90, 16384
buffer_load_dwordx4 v[176:179], v1, s[24:27], s58 offen sc1
v_mfma_f32_16x16x32_bf16 v[124:127], v[60:63], v[236:239], v[124:127]
s_setprio 3
s_waitcnt lgkmcnt(0)
s_waitcnt vmcnt(6)
v_add3_u32 v22, v144, v145, v146
v_add3_u32 v22, v22, v147, v148
v_add3_u32 v22, v22, v149, v150
v_add_u32 v22, v22, v151
v_add3_u32 v23, v152, v153, v154
v_add3_u32 v23, v23, v155, v156
v_add3_u32 v23, v23, v157, v158
v_add_u32 v23, v23, v159
s_nop 1
v_permlane32_swap_b32 v22, v23
v_add3_u32 v22, v22, v23, v8
v_cmp_ne_u32 vcc, v22, v244
s_cbranch_vccnz L_slow61
L_back62:
v_mfma_f32_16x16x32_bf16 v[96:99], v[32:35], v[144:147], v[96:99]
ds_read_b64_tr_b16 v[48:49], v2 offset:17408
ds_read_b64_tr_b16 v[50:51], v2 offset:21504
s_add_u32 s58, s90, 17408
buffer_load_dwordx4 v[180:183], v1, s[24:27], s58 offen sc1
v_mfma_f32_16x16x32_bf16 v[100:103], v[32:35], v[148:151], v[100:103]
ds_read_b64_tr_b16 v[52:53], v3 offset:17408
ds_read_b64_tr_b16 v[54:55], v3 offset:21504
v_mfma_f32_16x16x32_bf16 v[104:107], v[36:39], v[144:147], v[104:107]
ds_read_b64_tr_b16 v[56:57], v18 offset:17408
ds_read_b64_tr_b16 v[58:59], v18 offset:21504
v_mfma_f32_16x16x32_bf16 v[108:111], v[36:39], v[148:151], v[108:111]
ds_read_b64_tr_b16 v[60:61], v19 offset:17408
ds_read_b64_tr_b16 v[62:63], v19 offset:21504
v_mfma_f32_16x16x32_bf16 v[112:115], v[40:43], v[144:147], v[112:115]
s_add_u32 s58, s90, 18432
buffer_load_dwordx4 v[184:187], v1, s[24:27], s58 offen sc1
v_mfma_f32_16x16x32_bf16 v[116:119], v[40:43], v[148:151], v[116:119]
v_mfma_f32_16x16x32_bf16 v[120:123], v[44:47], v[144:147], v[120:123]
v_mfma_f32_16x16x32_bf16 v[124:127], v[44:47], v[148:151], v[124:127]
s_setprio 3
s_waitcnt lgkmcnt(0)
v_mfma_f32_16x16x32_bf16 v[96:99], v[48:51], v[152:155], v[96:99]
v_add_u32 v2, 0xfffe0000, v2
ds_read_b64_tr_b16 v[32:33], v2 offset:0
ds_read_b64_tr_b16 v[34:35], v2 offset:4096
v_mfma_f32_16x16x32_bf16 v[100:103], v[48:51], v[156:159], v[100:103]
v_add_u32 v3, 0xfffe0000, v3
ds_read_b64_tr_b16 v[36:37], v3 offset:0
ds_read_b64_tr_b16 v[38:39], v3 offset:4096
s_add_u32 s58, s90, 19456
buffer_load_dwordx4 v[188:191], v1, s[24:27], s58 offen sc1
buffer_load_dword v246, v9, s[24:27], s92 offen offset:1024 sc1
v_mfma_f32_16x16x32_bf16 v[104:107], v[52:55], v[152:155], v[104:107]
v_add_u32 v18, 0xfffe0000, v18
ds_read_b64_tr_b16 v[40:41], v18 offset:0
ds_read_b64_tr_b16 v[42:43], v18 offset:4096
v_mfma_f32_16x16x32_bf16 v[108:111], v[52:55], v[156:159], v[108:111]
v_add_u32 v19, 0xfffe0000, v19
ds_read_b64_tr_b16 v[44:45], v19 offset:0
ds_read_b64_tr_b16 v[46:47], v19 offset:4096
v_mfma_f32_16x16x32_bf16 v[112:115], v[56:59], v[152:155], v[112:115]
v_mfma_f32_16x16x32_bf16 v[116:119], v[56:59], v[156:159], v[116:119]
s_add_u32 s58, s90, 20480
buffer_load_dwordx4 v[192:195], v1, s[24:27], s58 offen sc1
v_mfma_f32_16x16x32_bf16 v[120:123], v[60:63], v[152:155], v[120:123]
v_mfma_f32_16x16x32_bf16 v[124:127], v[60:63], v[156:159], v[124:127]
s_setprio 2
s_waitcnt lgkmcnt(0)
s_waitcnt vmcnt(6)
v_add3_u32 v22, v160, v161, v162
v_add3_u32 v22, v22, v163, v164
v_add3_u32 v22, v22, v165, v166
v_add_u32 v22, v22, v167
v_add3_u32 v23, v168, v169, v170
v_add3_u32 v23, v23, v171, v172
v_add3_u32 v23, v23, v173, v174
v_add_u32 v23, v23, v175
s_nop 1
v_permlane32_swap_b32 v22, v23
v_add3_u32 v22, v22, v23, v8
v_cmp_ne_u32 vcc, v22, v245
s_cbranch_vccnz L_slow64
L_back65:
v_mfma_f32_16x16x32_bf16 v[96:99], v[32:35], v[160:163], v[96:99]
ds_read_b64_tr_b16 v[48:49], v2 offset:1024
ds_read_b64_tr_b16 v[50:51], v2 offset:5120
s_add_u32 s58, s90, 21504
buffer_load_dwordx4 v[196:199], v1, s[24:27], s58 offen sc1
v_mfma_f32_16x16x32_bf16 v[100:103], v[32:35], v[164:167], v[100:103]
ds_read_b64_tr_b16 v[52:53], v3 offset:1024
ds_read_b64_tr_b16 v[54:55], v3 offset:5120
v_mfma_f32_16x16x32_bf16 v[104:107], v[36:39], v[160:163], v[104:107]
ds_read_b64_tr_b16 v[56:57], v18 offset:1024
ds_read_b64_tr_b16 v[58:59], v18 offset:5120
v_mfma_f32_16x16x32_bf16 v[108:111], v[36:39], v[164:167], v[108:111]
ds_read_b64_tr_b16 v[60:61], v19 offset:1024
ds_read_b64_tr_b16 v[62:63], v19 offset:5120
s_add_u32 s58, s90, 22528
buffer_load_dwordx4 v[200:203], v1, s[24:27], s58 offen sc1
v_mfma_f32_16x16x32_bf16 v[112:115], v[40:43], v[160:163], v[112:115]
v_mfma_f32_16x16x32_bf16 v[116:119], v[40:43], v[164:167], v[116:119]
v_mfma_f32_16x16x32_bf16 v[120:123], v[44:47], v[160:163], v[120:123]
v_mfma_f32_16x16x32_bf16 v[124:127], v[44:47], v[164:167], v[124:127]
s_setprio 1
s_waitcnt lgkmcnt(0)
s_add_u32 s58, s90, 23552
buffer_load_dwordx4 v[204:207], v1, s[24:27], s58 offen sc1
buffer_load_dword v247, v9, s[24:27], s92 offen offset:1280 sc1
v_mfma_f32_16x16x32_bf16 v[96:99], v[48:51], v[168:171], v[96:99]
v_add_u32 v18, 0x10000, v18
ds_read_b64_tr_b16 v[32:33], v18 offset:0
ds_read_b64_tr_b16 v[34:35], v18 offset:4096
v_mfma_f32_16x16x32_bf16 v[100:103], v[48:51], v[172:175], v[100:103]
v_add_u32 v19, 0x10000, v19
ds_read_b64_tr_b16 v[36:37], v19 offset:0
ds_read_b64_tr_b16 v[38:39], v19 offset:4096
v_mfma_f32_16x16x32_bf16 v[104:107], v[52:55], v[168:171], v[104:107]
ds_read_b64_tr_b16 v[40:41], v18 offset:1024
ds_read_b64_tr_b16 v[42:43], v18 offset:5120
v_mfma_f32_16x16x32_bf16 v[108:111], v[52:55], v[172:175], v[108:111]
ds_read_b64_tr_b16 v[44:45], v19 offset:1024
ds_read_b64_tr_b16 v[46:47], v19 offset:5120
s_add_u32 s58, s90, 24576
buffer_load_dwordx4 v[208:211], v1, s[24:27], s58 offen sc1
v_mfma_f32_16x16x32_bf16 v[112:115], v[56:59], v[168:171], v[112:115]
v_mfma_f32_16x16x32_bf16 v[116:119], v[56:59], v[172:175], v[116:119]
v_mfma_f32_16x16x32_bf16 v[120:123], v[60:63], v[168:171], v[120:123]
v_mfma_f32_16x16x32_bf16 v[124:127], v[60:63], v[172:175], v[124:127]
s_setprio 0
s_waitcnt lgkmcnt(0)
s_add_u32 s58, s90, 25600
buffer_load_dwordx4 v[212:215], v1, s[24:27], s58 offen sc1
buffer_load_dword v248, v9, s[24:27], s92 offen offset:1536 sc1
s_waitcnt vmcnt(8)
v_add3_u32 v22, v176, v177, v178
v_add3_u32 v22, v22, v179, v180
v_add3_u32 v22, v22, v181, v182
v_add_u32 v22, v22, v183
v_add3_u32 v23, v184, v185, v186
v_add3_u32 v23, v23, v187, v188
v_add3_u32 v23, v23, v189, v190
v_add_u32 v23, v23, v191
s_nop 1
v_permlane32_swap_b32 v22, v23
v_add3_u32 v22, v22, v23, v8
v_cmp_ne_u32 vcc, v22, v246
s_cbranch_vccnz L_slow67
L_back68:
v_mfma_f32_16x16x32_bf16 v[112:115], v[32:35], v[176:179], v[112:115]
ds_read_b64_tr_b16 v[48:49], v18 offset:16384
ds_read_b64_tr_b16 v[50:51], v18 offset:20480
v_mfma_f32_16x16x32_bf16 v[116:119], v[32:35], v[180:183], v[116:119]
ds_read_b64_tr_b16 v[52:53], v19 offset:16384
ds_read_b64_tr_b16 v[54:55], v19 offset:20480
s_add_u32 s58, s90, 26624
buffer_load_dwordx4 v[216:219], v1, s[24:27], s58 offen sc1
v_mfma_f32_16x16x32_bf16 v[120:123], v[36:39], v[176:179], v[120:123]
ds_read_b64_tr_b16 v[56:57], v18 offset:17408
ds_read_b64_tr_b16 v[58:59], v18 offset:21504
v_mfma_f32_16x16x32_bf16 v[124:127], v[36:39], v[180:183], v[124:127]
ds_read_b64_tr_b16 v[60:61], v19 offset:17408
ds_read_b64_tr_b16 v[62:63], v19 offset:21504
v_mfma_f32_16x16x32_bf16 v[112:115], v[40:43], v[184:187], v[112:115]
v_mfma_f32_16x16x32_bf16 v[116:119], v[40:43], v[188:191], v[116:119]
v_mfma_f32_16x16x32_bf16 v[120:123], v[44:47], v[184:187], v[120:123]
s_add_u32 s58, s90, 27648
buffer_load_dwordx4 v[220:223], v1, s[24:27], s58 offen sc1
buffer_load_dword v249, v9, s[24:27], s92 offen offset:1792 sc1
v_mfma_f32_16x16x32_bf16 v[124:127], v[44:47], v[188:191], v[124:127]
s_waitcnt lgkmcnt(0)
s_barrier
s_setprio 3
s_waitcnt vmcnt(6)
v_add3_u32 v22, v192, v193, v194
v_add3_u32 v22, v22, v195, v196
v_add3_u32 v22, v22, v197, v198
v_add_u32 v22, v22, v199
v_add3_u32 v23, v200, v201, v202
v_add3_u32 v23, v23, v203, v204
v_add3_u32 v23, v23, v205, v206
v_add_u32 v23, v23, v207
s_nop 1
v_permlane32_swap_b32 v22, v23
v_add3_u32 v22, v22, v23, v8
v_cmp_ne_u32 vcc, v22, v247
s_cbranch_vccnz L_slow70
L_back71:
v_mfma_f32_16x16x32_bf16 v[112:115], v[48:51], v[192:195], v[112:115]
ds_read_b64_tr_b16 v[32:33], v18 offset:32768
ds_read_b64_tr_b16 v[34:35], v18 offset:36864
s_add_u32 s58, s90, 28672
buffer_load_dwordx4 v[224:227], v1, s[24:27], s58 offen sc1
v_mfma_f32_16x16x32_bf16 v[116:119], v[48:51], v[196:199], v[116:119]
ds_read_b64_tr_b16 v[36:37], v19 offset:32768
ds_read_b64_tr_b16 v[38:39], v19 offset:36864
v_mfma_f32_16x16x32_bf16 v[120:123], v[52:55], v[192:195], v[120:123]
ds_read_b64_tr_b16 v[40:41], v18 offset:33792
ds_read_b64_tr_b16 v[42:43], v18 offset:37888
s_add_u32 s58, s90, 29696
buffer_load_dwordx4 v[228:231], v1, s[24:27], s58 offen sc1
v_mfma_f32_16x16x32_bf16 v[124:127], v[52:55], v[196:199], v[124:127]
ds_read_b64_tr_b16 v[44:45], v19 offset:33792
ds_read_b64_tr_b16 v[46:47], v19 offset:37888
v_mfma_f32_16x16x32_bf16 v[112:115], v[56:59], v[200:203], v[112:115]
s_add_u32 s58, s90, 30720
buffer_load_dwordx4 v[232:235], v1, s[24:27], s58 offen sc1
v_mfma_f32_16x16x32_bf16 v[116:119], v[56:59], v[204:207], v[116:119]
s_add_u32 s58, s90, 31744
buffer_load_dwordx4 v[236:239], v1, s[24:27], s58 offen sc1
buffer_load_dword v250, v9, s[24:27], s92 offen offset:2048 sc1
v_mfma_f32_16x16x32_bf16 v[120:123], v[60:63], v[200:203], v[120:123]
v_mfma_f32_16x16x32_bf16 v[124:127], v[60:63], v[204:207], v[124:127]
s_setprio 3
s_waitcnt lgkmcnt(0)
s_waitcnt vmcnt(8)
v_add3_u32 v22, v208, v209, v210
v_add_u32 v22, v22, v211
v_add3_u32 v23, v212, v213, v214
v_add_u32 v23, v23, v215
s_nop 1
v_permlane32_swap_b32 v22, v23
v_add3_u32 v22, v22, v23, v8
v_cmp_ne_u32 vcc, v22, v248
s_cbranch_vccnz L_slow73
L_back74:
v_swap_b32 v210, v212
v_swap_b32 v211, v213
s_nop 1
v_mfma_f32_16x16x32_bf16 v[112:115], v[32:35], v[208:211], v[112:115]
ds_read_b64_tr_b16 v[48:49], v18 offset:49152
ds_read_b64_tr_b16 v[50:51], v18 offset:53248
v_mfma_f32_16x16x32_bf16 v[116:119], v[32:35], v[212:215], v[116:119]
ds_read_b64_tr_b16 v[52:53], v19 offset:49152
ds_read_b64_tr_b16 v[54:55], v19 offset:53248
v_mfma_f32_16x16x32_bf16 v[120:123], v[36:39], v[208:211], v[120:123]
ds_read_b64_tr_b16 v[56:57], v18 offset:50176
ds_read_b64_tr_b16 v[58:59], v18 offset:54272
v_mfma_f32_16x16x32_bf16 v[124:127], v[36:39], v[212:215], v[124:127]
ds_read_b64_tr_b16 v[60:61], v19 offset:50176
ds_read_b64_tr_b16 v[62:63], v19 offset:54272
s_waitcnt vmcnt(5)
v_add3_u32 v22, v216, v217, v218
v_add_u32 v22, v22, v219
v_add3_u32 v23, v220, v221, v222
v_add_u32 v23, v23, v223
s_nop 1
v_permlane32_swap_b32 v22, v23
v_add3_u32 v22, v22, v23, v8
v_cmp_ne_u32 vcc, v22, v249
s_cbranch_vccnz L_slow76
L_back77:
v_swap_b32 v218, v220
v_swap_b32 v219, v221
s_nop 1
v_mfma_f32_16x16x32_bf16 v[112:115], v[40:43], v[216:219], v[112:115]
s_add_u32 s58, s90, 32768
buffer_load_dwordx4 v[144:147], v1, s[24:27], s58 offen sc1
v_mfma_f32_16x16x32_bf16 v[116:119], v[40:43], v[220:223], v[116:119]
s_add_u32 s58, s90, 33792
buffer_load_dwordx4 v[148:151], v1, s[24:27], s58 offen sc1
v_mfma_f32_16x16x32_bf16 v[120:123], v[44:47], v[216:219], v[120:123]
s_add_u32 s58, s90, 34816
buffer_load_dwordx4 v[152:155], v1, s[24:27], s58 offen sc1
v_mfma_f32_16x16x32_bf16 v[124:127], v[44:47], v[220:223], v[124:127]
s_setprio 3
s_waitcnt lgkmcnt(0)
s_add_u32 s58, s90, 35840
buffer_load_dwordx4 v[156:159], v1, s[24:27], s58 offen sc1
buffer_load_dword v251, v9, s[24:27], s92 offen offset:2304 sc1
s_waitcnt vmcnt(5)
v_add3_u32 v22, v224, v225, v226
v_add3_u32 v22, v22, v227, v228
v_add3_u32 v22, v22, v229, v230
v_add_u32 v22, v22, v231
v_add3_u32 v23, v232, v233, v234
v_add3_u32 v23, v23, v235, v236
v_add3_u32 v23, v23, v237, v238
v_add_u32 v23, v23, v239
s_nop 1
v_permlane32_swap_b32 v22, v23
v_add3_u32 v22, v22, v23, v8
v_cmp_ne_u32 vcc, v22, v250
s_cbranch_vccnz L_slow79
L_back80:
v_mfma_f32_16x16x32_bf16 v[112:115], v[48:51], v[224:227], v[112:115]
v_add_u32 v18, 0xffff0000, v18
ds_read_b64_tr_b16 v[32:33], v18 offset:16384
ds_read_b64_tr_b16 v[34:35], v18 offset:20480
v_mfma_f32_16x16x32_bf16 v[116:119], v[48:51], v[228:231], v[116:119]
v_add_u32 v19, 0xffff0000, v19
ds_read_b64_tr_b16 v[36:37], v19 offset:16384
ds_read_b64_tr_b16 v[38:39], v19 offset:20480
v_mfma_f32_16x16x32_bf16 v[120:123], v[52:55], v[224:227], v[120:123]
ds_read_b64_tr_b16 v[40:41], v18 offset:17408
ds_read_b64_tr_b16 v[42:43], v18 offset:21504
v_and_b32 v88, 0xf0, v1
v_lshlrev_b32 v88, 7, v88
v_bfe_u32 v89, v1, 8, 1
v_mfma_f32_16x16x32_bf16 v[124:127], v[52:55], v[228:231], v[124:127]
ds_read_b64_tr_b16 v[44:45], v19 offset:17408
ds_read_b64_tr_b16 v[46:47], v19 offset:21504
v_lshl_add_u32 v88, v89, 5, v88
v_lshrrev_b32 v89, 9, v1
v_lshl_add_u32 v88, v89, 4, v88
v_mfma_f32_16x16x32_bf16 v[112:115], v[56:59], v[232:235], v[112:115]
buffer_load_dwordx4 v[76:79], v88, s[4:7], s91 offen
v_mfma_f32_16x16x32_bf16 v[116:119], v[56:59], v[236:239], v[116:119]
s_lshl_b32 s58, s43, 12
s_add_u32 s58, s58, 0
s_mul_i32 s57, s44, 32768
s_add_u32 s57, s57, s58
v_add_u32 v90, s57, v1
v_mfma_f32_16x16x32_bf16 v[120:123], v[60:63], v[232:235], v[120:123]
s_lshl_b32 s58, s43, 12
s_add_u32 s58, s58, 0
s_xor_b32 s57, s44, 1
s_mul_i32 s57, s57, 32768
s_add_u32 s57, s57, s58
v_add_u32 v91, s57, v1
v_mfma_f32_16x16x32_bf16 v[124:127], v[60:63], v[236:239], v[124:127]
s_setprio 3
s_waitcnt lgkmcnt(0)
s_mov_b32 s68, 0x7060500
s_mov_b32 s69, 0x7060501
s_mov_b32 s70, 0x7060502
s_mov_b32 s71, 0x7060503
s_waitcnt vmcnt(1)
v_add3_u32 v22, v144, v145, v146
v_add3_u32 v22, v22, v147, v148
v_add3_u32 v22, v22, v149, v150
v_add_u32 v22, v22, v151
v_add3_u32 v23, v152, v153, v154
v_add3_u32 v23, v23, v155, v156
v_add3_u32 v23, v23, v157, v158
v_add_u32 v23, v23, v159
s_nop 1
v_permlane32_swap_b32 v22, v23
v_add3_u32 v22, v22, v23, v8
v_cmp_ne_u32 vcc, v22, v251
s_cbranch_vccnz L_slow82
L_back83:
v_mfma_f32_16x16x32_bf16 v[112:115], v[32:35], v[144:147], v[112:115]
v_add_u32 v2, 0x10000, v2
ds_read_b64_tr_b16 v[48:49], v2 offset:0
ds_read_b64_tr_b16 v[50:51], v2 offset:4096
s_mov_b32 s72, 0x0c0c0400
s_mov_b32 s73, 0x04000c0c
s_add_u32 s93, s93, 0x1000000
s_xor_b32 s61, s93, 0x10000
s_xor_b32 s82, s61, 0x4000
v_mfma_f32_16x16x32_bf16 v[116:119], v[32:35], v[148:151], v[116:119]
v_add_u32 v3, 0x10000, v3
ds_read_b64_tr_b16 v[52:53], v3 offset:0
ds_read_b64_tr_b16 v[54:55], v3 offset:4096
v_mfma_f32_16x16x32_bf16 v[120:123], v[36:39], v[144:147], v[120:123]
ds_read_b64_tr_b16 v[56:57], v2 offset:1024
ds_read_b64_tr_b16 v[58:59], v2 offset:5120
v_mfma_f32_16x16x32_bf16 v[124:127], v[36:39], v[148:151], v[124:127]
ds_read_b64_tr_b16 v[60:61], v3 offset:1024
ds_read_b64_tr_b16 v[62:63], v3 offset:5120
v_mfma_f32_16x16x32_bf16 v[112:115], v[40:43], v[152:155], v[112:115]
v_mfma_f32_16x16x32_bf16 v[116:119], v[40:43], v[156:159], v[116:119]
v_mfma_f32_16x16x32_bf16 v[120:123], v[44:47], v[152:155], v[120:123]
v_mfma_f32_16x16x32_bf16 v[124:127], v[44:47], v[156:159], v[124:127]
s_setprio 3
s_waitcnt lgkmcnt(0)
v_mfma_f32_16x16x32_bf16 v[96:99], v[48:51], v[176:179], v[96:99]
ds_read_b64_tr_b16 v[32:33], v2 offset:16384
ds_read_b64_tr_b16 v[34:35], v2 offset:20480
v_mfma_f32_16x16x32_bf16 v[100:103], v[48:51], v[180:183], v[100:103]
ds_read_b64_tr_b16 v[36:37], v3 offset:16384
ds_read_b64_tr_b16 v[38:39], v3 offset:20480
ds_write_b128 v90, v[116:119] offset:2048
ds_write_b128 v90, v[124:127] offset:3072
v_mfma_f32_16x16x32_bf16 v[104:107], v[52:55], v[176:179], v[104:107]
ds_read_b64_tr_b16 v[40:41], v2 offset:17408
ds_read_b64_tr_b16 v[42:43], v2 offset:21504
v_mfma_f32_16x16x32_bf16 v[108:111], v[52:55], v[180:183], v[108:111]
ds_read_b64_tr_b16 v[44:45], v3 offset:17408
ds_read_b64_tr_b16 v[46:47], v3 offset:21504
s_waitcnt lgkmcnt(4)
s_barrier
ds_read_b128 v[136:139], v91 offset:2048
ds_read_b128 v[140:143], v91 offset:3072
v_mfma_f32_16x16x32_bf16 v[96:99], v[56:59], v[184:187], v[96:99]
v_mfma_f32_16x16x32_bf16 v[100:103], v[56:59], v[188:191], v[100:103]
s_waitcnt lgkmcnt(1)
v_add_f32 v112, v112, v136
v_add_f32 v113, v113, v137
v_add_f32 v114, v114, v138
v_add_f32 v115, v115, v139
v_mfma_f32_16x16x32_bf16 v[104:107], v[60:63], v[184:187], v[104:107]
s_waitcnt lgkmcnt(0)
v_add_f32 v120, v120, v140
v_add_f32 v121, v121, v141
v_add_f32 v122, v122, v142
v_add_f32 v123, v123, v143
v_mfma_f32_16x16x32_bf16 v[108:111], v[60:63], v[188:191], v[108:111]
s_setprio 3
v_cvt_pk_bf16_f32 v112, v112, v113
v_cvt_pk_bf16_f32 v113, v114, v115
v_cvt_pk_bf16_f32 v114, v120, v121
v_cvt_pk_bf16_f32 v115, v122, v123
v_mfma_f32_16x16x32_bf16 v[96:99], v[32:35], v[192:195], v[96:99]
ds_read_b64_tr_b16 v[48:49], v2 offset:32768
ds_read_b64_tr_b16 v[50:51], v2 offset:36864
buffer_store_dwordx4 v[112:115], v1, s[24:27], s93 offen offset:0 sc1
v_add3_u32 v120, v8, v112, v113
v_add3_u32 v120, v120, v114, v115
buffer_store_dword v120, v9, s[24:27], s93 offen offset:1024 sc1
v_mfma_f32_16x16x32_bf16 v[100:103], v[32:35], v[196:199], v[100:103]
ds_read_b64_tr_b16 v[52:53], v3 offset:32768
ds_read_b64_tr_b16 v[54:55], v3 offset:36864
v_mfma_f32_16x16x32_bf16 v[104:107], v[36:39], v[192:195], v[104:107]
ds_read_b64_tr_b16 v[56:57], v2 offset:33792
ds_read_b64_tr_b16 v[58:59], v2 offset:37888
v_mfma_f32_16x16x32_bf16 v[108:111], v[36:39], v[196:199], v[108:111]
ds_read_b64_tr_b16 v[60:61], v3 offset:33792
ds_read_b64_tr_b16 v[62:63], v3 offset:37888
v_mfma_f32_16x16x32_bf16 v[96:99], v[40:43], v[200:203], v[96:99]
v_mfma_f32_16x16x32_bf16 v[100:103], v[40:43], v[204:207], v[100:103]
v_mfma_f32_16x16x32_bf16 v[104:107], v[44:47], v[200:203], v[104:107]
v_mfma_f32_16x16x32_bf16 v[108:111], v[44:47], v[204:207], v[108:111]
s_setprio 2
s_waitcnt lgkmcnt(0)
v_mfma_f32_16x16x32_bf16 v[96:99], v[48:51], v[208:211], v[96:99]
ds_read_b64_tr_b16 v[32:33], v2 offset:49152
ds_read_b64_tr_b16 v[34:35], v2 offset:53248
v_mfma_f32_16x16x32_bf16 v[100:103], v[48:51], v[212:215], v[100:103]
ds_read_b64_tr_b16 v[36:37], v3 offset:49152
ds_read_b64_tr_b16 v[38:39], v3 offset:53248
v_mfma_f32_16x16x32_bf16 v[104:107], v[52:55], v[208:211], v[104:107]
ds_read_b64_tr_b16 v[40:41], v2 offset:50176
ds_read_b64_tr_b16 v[42:43], v2 offset:54272
v_mfma_f32_16x16x32_bf16 v[108:111], v[52:55], v[212:215], v[108:111]
ds_read_b64_tr_b16 v[44:45], v3 offset:50176
ds_read_b64_tr_b16 v[46:47], v3 offset:54272
v_mfma_f32_16x16x32_bf16 v[96:99], v[56:59], v[216:219], v[96:99]
v_mfma_f32_16x16x32_bf16 v[100:103], v[56:59], v[220:223], v[100:103]
v_mfma_f32_16x16x32_bf16 v[104:107], v[60:63], v[216:219], v[104:107]
s_waitcnt vmcnt(2)
v_permlane16_swap_b32 v76, v78
v_mfma_f32_16x16x32_bf16 v[108:111], v[60:63], v[220:223], v[108:111]
s_setprio 1
s_waitcnt lgkmcnt(0)
v_permlane16_swap_b32 v77, v79
v_mfma_f32_16x16x32_bf16 v[96:99], v[32:35], v[224:227], v[96:99]
v_add_u32 v2, 0xffff0000, v2
ds_read_b64_tr_b16 v[48:49], v2 offset:16384
ds_read_b64_tr_b16 v[50:51], v2 offset:20480
v_lshlrev_b32 v64, 16, v76
v_mfma_f32_16x16x32_bf16 v[100:103], v[32:35], v[228:231], v[100:103]
v_add_u32 v3, 0xffff0000, v3
ds_read_b64_tr_b16 v[52:53], v3 offset:16384
ds_read_b64_tr_b16 v[54:55], v3 offset:20480
v_and_b32 v65, 0xffff0000, v76
v_mfma_f32_16x16x32_bf16 v[104:107], v[36:39], v[224:227], v[104:107]
ds_read_b64_tr_b16 v[56:57], v2 offset:17408
ds_read_b64_tr_b16 v[58:59], v2 offset:21504
v_lshlrev_b32 v66, 16, v77
v_mfma_f32_16x16x32_bf16 v[108:111], v[36:39], v[228:231], v[108:111]
ds_read_b64_tr_b16 v[60:61], v3 offset:17408
ds_read_b64_tr_b16 v[62:63], v3 offset:21504
v_and_b32 v67, 0xffff0000, v77
v_mfma_f32_16x16x32_bf16 v[96:99], v[40:43], v[232:235], v[96:99]
v_lshlrev_b32 v68, 16, v78
v_mfma_f32_16x16x32_bf16 v[100:103], v[40:43], v[236:239], v[100:103]
v_and_b32 v69, 0xffff0000, v78
v_mfma_f32_16x16x32_bf16 v[104:107], v[44:47], v[232:235], v[104:107]
v_lshlrev_b32 v70, 16, v79
v_mfma_f32_16x16x32_bf16 v[108:111], v[44:47], v[236:239], v[108:111]
s_setprio 0
s_waitcnt lgkmcnt(0)
v_and_b32 v71, 0xffff0000, v79
v_mfma_f32_16x16x32_bf16 v[96:99], v[48:51], v[144:147], v[96:99]
v_mfma_f32_16x16x32_bf16 v[100:103], v[48:51], v[148:151], v[100:103]
v_mfma_f32_16x16x32_bf16 v[104:107], v[52:55], v[144:147], v[104:107]
buffer_load_dwordx4 v[240:243], v1, s[24:27], s61 offen sc1
buffer_load_dword v248, v9, s[24:27], s61 offen offset:1024 sc1
v_mfma_f32_16x16x32_bf16 v[108:111], v[52:55], v[148:151], v[108:111]
v_mfma_f32_16x16x32_bf16 v[96:99], v[56:59], v[152:155], v[96:99]
v_mfma_f32_16x16x32_bf16 v[100:103], v[56:59], v[156:159], v[100:103]
v_mfma_f32_16x16x32_bf16 v[104:107], v[60:63], v[152:155], v[104:107]
v_mfma_f32_16x16x32_bf16 v[108:111], v[60:63], v[156:159], v[108:111]
s_nop 5
ds_write_b128 v90, v[100:103] offset:0
s_nop 0
ds_write_b128 v90, v[108:111] offset:1024
s_waitcnt lgkmcnt(0)
s_barrier
ds_read_b128 v[128:131], v91 offset:0
ds_read_b128 v[132:135], v91 offset:1024
v_add_f32 v64, v64, v96
v_add_f32 v65, v65, v97
v_add_f32 v66, v66, v98
v_add_f32 v67, v67, v99
s_waitcnt lgkmcnt(1)
v_add_f32 v64, v64, v128
v_add_f32 v65, v65, v129
v_add_f32 v66, v66, v130
v_add_f32 v67, v67, v131
v_add_f32 v68, v68, v104
v_add_f32 v69, v69, v105
v_add_f32 v70, v70, v106
v_add_f32 v71, v71, v107
s_waitcnt lgkmcnt(0)
v_add_f32 v68, v68, v132
v_add_f32 v69, v69, v133
v_add_f32 v70, v70, v134
v_add_f32 v71, v71, v135
s_waitcnt vmcnt(0)
v_sub_u32 v250, v248, v8
v_add3_u32 v251, v240, v241, v242
v_add_u32 v251, v251, v243
v_cmp_ne_u32 vcc, v250, v251
s_cbranch_vccnz L_slow113
L_back114:
v_lshlrev_b32 v128, 16, v240
v_and_b32 v129, 0xffff0000, v240
v_lshlrev_b32 v130, 16, v241
v_and_b32 v131, 0xffff0000, v241
v_lshlrev_b32 v132, 16, v242
v_and_b32 v133, 0xffff0000, v242
v_lshlrev_b32 v134, 16, v243
v_and_b32 v135, 0xffff0000, v243
v_add_f32 v64, v64, v128
v_add_f32 v65, v65, v129
v_add_f32 v66, v66, v130
v_add_f32 v67, v67, v131
v_add_f32 v68, v68, v132
v_add_f32 v69, v69, v133
v_add_f32 v70, v70, v134
v_add_f32 v71, v71, v135
v_cvt_pk_bf16_f32 v72, v64, v65
v_cvt_pk_bf16_f32 v73, v66, v67
v_cvt_pk_bf16_f32 v74, v68, v69
v_cvt_pk_bf16_f32 v75, v70, v71
s_nop 0
v_permlane16_swap_b32 v72, v74
v_permlane16_swap_b32 v73, v75
buffer_store_dwordx4 v[72:75], v88, s[28:31], s91 offen
s_endpgm
L_slow2:
s_mov_b32 s87, 0
L_loop4:
s_nop 1
s_add_u32 s58, s90, 8192
buffer_load_dwordx4 v[144:147], v1, s[24:27], s58 offen sc1
s_add_u32 s58, s90, 9216
buffer_load_dwordx4 v[148:151], v1, s[24:27], s58 offen sc1
s_add_u32 s58, s90, 10240
buffer_load_dwordx4 v[152:155], v1, s[24:27], s58 offen sc1
s_add_u32 s58, s90, 11264
buffer_load_dwordx4 v[156:159], v1, s[24:27], s58 offen sc1
buffer_load_dword v10, v9, s[24:27], s92 offen offset:512 sc1
s_add_u32 s58, s90, 12288
buffer_load_dwordx4 v[160:163], v1, s[24:27], s58 offen sc1
s_add_u32 s58, s90, 13312
buffer_load_dwordx4 v[164:167], v1, s[24:27], s58 offen sc1
s_add_u32 s58, s90, 14336
buffer_load_dwordx4 v[168:171], v1, s[24:27], s58 offen sc1
s_add_u32 s58, s90, 15360
buffer_load_dwordx4 v[172:175], v1, s[24:27], s58 offen sc1
buffer_load_dword v11, v9, s[24:27], s92 offen offset:768 sc1
s_waitcnt vmcnt(0)
v_add3_u32 v22, v144, v145, v146
v_add3_u32 v22, v22, v147, v148
v_add3_u32 v22, v22, v149, v150
v_add_u32 v22, v22, v151
v_add3_u32 v23, v152, v153, v154
v_add3_u32 v23, v23, v155, v156
v_add3_u32 v23, v23, v157, v158
v_add_u32 v23, v23, v159
s_nop 1
v_permlane32_swap_b32 v22, v23
v_add3_u32 v22, v22, v23, v8
v_cmp_ne_u32 vcc, v22, v10
s_cbranch_vccz L_back3z
s_add_u32 s87, s87, 1
s_cmp_lt_u32 s87, 0x8000
s_cbranch_scc1 L_loop4
L_back3z:
s_nop 7
s_branch L_back3
L_slow5:
s_mov_b32 s87, 0
L_loop7:
s_nop 1
s_add_u32 s58, s90, 12288
buffer_load_dwordx4 v[160:163], v1, s[24:27], s58 offen sc1
s_add_u32 s58, s90, 13312
buffer_load_dwordx4 v[164:167], v1, s[24:27], s58 offen sc1
s_add_u32 s58, s90, 14336
buffer_load_dwordx4 v[168:171], v1, s[24:27], s58 offen sc1
s_add_u32 s58, s90, 15360
buffer_load_dwordx4 v[172:175], v1, s[24:27], s58 offen sc1
buffer_load_dword v11, v9, s[24:27], s92 offen offset:768 sc1
s_waitcnt vmcnt(0)
v_add3_u32 v22, v160, v161, v162
v_add3_u32 v22, v22, v163, v164
v_add3_u32 v22, v22, v165, v166
v_add_u32 v22, v22, v167
v_add3_u32 v23, v168, v169, v170
v_add3_u32 v23, v23, v171, v172
v_add3_u32 v23, v23, v173, v174
v_add_u32 v23, v23, v175
s_nop 1
v_permlane32_swap_b32 v22, v23
v_add3_u32 v22, v22, v23, v8
v_cmp_ne_u32 vcc, v22, v11
s_cbranch_vccz L_back6z
s_add_u32 s87, s87, 1
s_cmp_lt_u32 s87, 0x8000
s_cbranch_scc1 L_loop7
L_back6z:
s_nop 7
s_branch L_back6
L_slow8:
s_mov_b32 s87, 0
L_loop10:
s_nop 1
s_add_u32 s58, s90, 16384
buffer_load_dwordx4 v[176:179], v1, s[24:27], s58 offen sc1
s_add_u32 s58, s90, 17408
buffer_load_dwordx4 v[180:183], v1, s[24:27], s58 offen sc1
s_add_u32 s58, s90, 18432
buffer_load_dwordx4 v[184:187], v1, s[24:27], s58 offen sc1
s_add_u32 s58, s90, 19456
buffer_load_dwordx4 v[188:191], v1, s[24:27], s58 offen sc1
buffer_load_dword v12, v9, s[24:27], s92 offen offset:1024 sc1
s_add_u32 s58, s90, 20480
buffer_load_dwordx4 v[192:195], v1, s[24:27], s58 offen sc1
s_add_u32 s58, s90, 21504
buffer_load_dwordx4 v[196:199], v1, s[24:27], s58 offen sc1
s_add_u32 s58, s90, 22528
buffer_load_dwordx4 v[200:203], v1, s[24:27], s58 offen sc1
s_add_u32 s58, s90, 23552
buffer_load_dwordx4 v[204:207], v1, s[24:27], s58 offen sc1
buffer_load_dword v13, v9, s[24:27], s92 offen offset:1280 sc1
s_waitcnt vmcnt(0)
v_add3_u32 v22, v176, v177, v178
v_add3_u32 v22, v22, v179, v180
v_add3_u32 v22, v22, v181, v182
v_add_u32 v22, v22, v183
v_add3_u32 v23, v184, v185, v186
v_add3_u32 v23, v23, v187, v188
v_add3_u32 v23, v23, v189, v190
v_add_u32 v23, v23, v191
s_nop 1
v_permlane32_swap_b32 v22, v23
v_add3_u32 v22, v22, v23, v8
v_cmp_ne_u32 vcc, v22, v12
s_cbranch_vccz L_back9z
s_add_u32 s87, s87, 1
s_cmp_lt_u32 s87, 0x8000
s_cbranch_scc1 L_loop10
L_back9z:
s_nop 7
s_branch L_back9
L_slow11:
s_mov_b32 s87, 0
L_loop13:
s_nop 1
s_add_u32 s58, s90, 20480
buffer_load_dwordx4 v[192:195], v1, s[24:27], s58 offen sc1
s_add_u32 s58, s90, 21504
buffer_load_dwordx4 v[196:199], v1, s[24:27], s58 offen sc1
s_add_u32 s58, s90, 22528
buffer_load_dwordx4 v[200:203], v1, s[24:27], s58 offen sc1
s_add_u32 s58, s90, 23552
buffer_load_dwordx4 v[204:207], v1, s[24:27], s58 offen sc1
buffer_load_dword v13, v9, s[24:27], s92 offen offset:1280 sc1
s_waitcnt vmcnt(0)
v_add3_u32 v22, v192, v193, v194
v_add3_u32 v22, v22, v195, v196
v_add3_u32 v22, v22, v197, v198
v_add_u32 v22, v22, v199
v_add3_u32 v23, v200, v201, v202
v_add3_u32 v23, v23, v203, v204
v_add3_u32 v23, v23, v205, v206
v_add_u32 v23, v23, v207
s_nop 1
v_permlane32_swap_b32 v22, v23
v_add3_u32 v22, v22, v23, v8
v_cmp_ne_u32 vcc, v22, v13
s_cbranch_vccz L_back12z
s_add_u32 s87, s87, 1
s_cmp_lt_u32 s87, 0x8000
s_cbranch_scc1 L_loop13
L_back12z:
s_nop 7
s_branch L_back12
L_slow14:
s_mov_b32 s87, 0
L_loop16:
s_nop 1
s_add_u32 s58, s90, 24576
buffer_load_dwordx4 v[208:211], v1, s[24:27], s58 offen sc1
s_add_u32 s58, s90, 25600
buffer_load_dwordx4 v[212:215], v1, s[24:27], s58 offen sc1
buffer_load_dword v4, v9, s[24:27], s92 offen offset:1536 sc1
s_add_u32 s58, s90, 26624
buffer_load_dwordx4 v[216:219], v1, s[24:27], s58 offen sc1
s_add_u32 s58, s90, 27648
buffer_load_dwordx4 v[220:223], v1, s[24:27], s58 offen sc1
buffer_load_dword v20, v9, s[24:27], s92 offen offset:1792 sc1
s_waitcnt vmcnt(0)
v_add3_u32 v22, v208, v209, v210
v_add_u32 v22, v22, v211
v_add3_u32 v23, v212, v213, v214
v_add_u32 v23, v23, v215
s_nop 1
v_permlane32_swap_b32 v22, v23
v_add3_u32 v22, v22, v23, v8
v_cmp_ne_u32 vcc, v22, v4
s_cbranch_vccz L_back15z
s_add_u32 s87, s87, 1
s_cmp_lt_u32 s87, 0x8000
s_cbranch_scc1 L_loop16
L_back15z:
s_nop 7
s_branch L_back15
L_slow17:
s_mov_b32 s87, 0
L_loop19:
s_nop 1
s_add_u32 s58, s90, 26624
buffer_load_dwordx4 v[216:219], v1, s[24:27], s58 offen sc1
s_add_u32 s58, s90, 27648
buffer_load_dwordx4 v[220:223], v1, s[24:27], s58 offen sc1
buffer_load_dword v20, v9, s[24:27], s92 offen offset:1792 sc1
s_waitcnt vmcnt(0)
v_add3_u32 v22, v216, v217, v218
v_add_u32 v22, v22, v219
v_add3_u32 v23, v220, v221, v222
v_add_u32 v23, v23, v223
s_nop 1
v_permlane32_swap_b32 v22, v23
v_add3_u32 v22, v22, v23, v8
v_cmp_ne_u32 vcc, v22, v20
s_cbranch_vccz L_back18z
s_add_u32 s87, s87, 1
s_cmp_lt_u32 s87, 0x8000
s_cbranch_scc1 L_loop19
L_back18z:
s_nop 7
s_branch L_back18
L_slow20:
s_mov_b32 s87, 0
L_loop22:
s_nop 1
s_add_u32 s58, s90, 28672
buffer_load_dwordx4 v[224:227], v1, s[24:27], s58 offen sc1
s_add_u32 s58, s90, 29696
buffer_load_dwordx4 v[228:231], v1, s[24:27], s58 offen sc1
s_add_u32 s58, s90, 30720
buffer_load_dwordx4 v[232:235], v1, s[24:27], s58 offen sc1
s_add_u32 s58, s90, 31744
buffer_load_dwordx4 v[236:239], v1, s[24:27], s58 offen sc1
buffer_load_dword v7, v9, s[24:27], s92 offen offset:2048 sc1
s_add_u32 s58, s90, 32768
buffer_load_dwordx4 v[144:147], v1, s[24:27], s58 offen sc1
s_add_u32 s58, s90, 33792
buffer_load_dwordx4 v[148:151], v1, s[24:27], s58 offen sc1
s_add_u32 s58, s90, 34816
buffer_load_dwordx4 v[152:155], v1, s[24:27], s58 offen sc1
s_add_u32 s58, s90, 35840
buffer_load_dwordx4 v[156:159], v1, s[24:27], s58 offen sc1
buffer_load_dword v24, v9, s[24:27], s92 offen offset:2304 sc1
s_waitcnt vmcnt(0)
v_add3_u32 v22, v224, v225, v226
v_add3_u32 v22, v22, v227, v228
v_add3_u32 v22, v22, v229, v230
v_add_u32 v22, v22, v231
v_add3_u32 v23, v232, v233, v234
v_add3_u32 v23, v23, v235, v236
v_add3_u32 v23, v23, v237, v238
v_add_u32 v23, v23, v239
s_nop 1
v_permlane32_swap_b32 v22, v23
v_add3_u32 v22, v22, v23, v8
v_cmp_ne_u32 vcc, v22, v7
s_cbranch_vccz L_back21z
s_add_u32 s87, s87, 1
s_cmp_lt_u32 s87, 0x8000
s_cbranch_scc1 L_loop22
L_back21z:
s_nop 7
s_branch L_back21
L_slow23:
s_mov_b32 s87, 0
L_loop25:
s_nop 1
s_add_u32 s58, s90, 32768
buffer_load_dwordx4 v[144:147], v1, s[24:27], s58 offen sc1
s_add_u32 s58, s90, 33792
buffer_load_dwordx4 v[148:151], v1, s[24:27], s58 offen sc1
s_add_u32 s58, s90, 34816
buffer_load_dwordx4 v[152:155], v1, s[24:27], s58 offen sc1
s_add_u32 s58, s90, 35840
buffer_load_dwordx4 v[156:159], v1, s[24:27], s58 offen sc1
buffer_load_dword v24, v9, s[24:27], s92 offen offset:2304 sc1
s_waitcnt vmcnt(0)
v_add3_u32 v22, v144, v145, v146
v_add3_u32 v22, v22, v147, v148
v_add3_u32 v22, v22, v149, v150
v_add_u32 v22, v22, v151
v_add3_u32 v23, v152, v153, v154
v_add3_u32 v23, v23, v155, v156
v_add3_u32 v23, v23, v157, v158
v_add_u32 v23, v23, v159
s_nop 1
v_permlane32_swap_b32 v22, v23
v_add3_u32 v22, v22, v23, v8
v_cmp_ne_u32 vcc, v22, v24
s_cbranch_vccz L_back24z
s_add_u32 s87, s87, 1
s_cmp_lt_u32 s87, 0x8000
s_cbranch_scc1 L_loop25
L_back24z:
s_nop 7
s_branch L_back24
L_slow28:
s_mov_b32 s87, 0
L_loop30:
s_nop 1
s_add_u32 s58, s90, 0
buffer_load_dwordx4 v[208:211], v1, s[24:27], s58 offen sc1
s_add_u32 s58, s90, 1024
buffer_load_dwordx4 v[212:215], v1, s[24:27], s58 offen sc1
s_add_u32 s58, s90, 2048
buffer_load_dwordx4 v[216:219], v1, s[24:27], s58 offen sc1
s_add_u32 s58, s90, 3072
buffer_load_dwordx4 v[220:223], v1, s[24:27], s58 offen sc1
buffer_load_dword v18, v9, s[24:27], s92 offen offset:0 sc1
s_add_u32 s58, s90, 4096
buffer_load_dwordx4 v[224:227], v1, s[24:27], s58 offen sc1
s_add_u32 s58, s90, 5120
buffer_load_dwordx4 v[228:231], v1, s[24:27], s58 offen sc1
s_add_u32 s58, s90, 6144
buffer_load_dwordx4 v[232:235], v1, s[24:27], s58 offen sc1
s_add_u32 s58, s90, 7168
buffer_load_dwordx4 v[236:239], v1, s[24:27], s58 offen sc1
buffer_load_dword v19, v9, s[24:27], s92 offen offset:256 sc1
s_waitcnt vmcnt(0)
v_add3_u32 v22, v208, v209, v210
v_add3_u32 v22, v22, v211, v212
v_add3_u32 v22, v22, v213, v214
v_add_u32 v22, v22, v215
v_add3_u32 v23, v216, v217, v218
v_add3_u32 v23, v23, v219, v220
v_add3_u32 v23, v23, v221, v222
v_add_u32 v23, v23, v223
s_nop 1
v_permlane32_swap_b32 v22, v23
v_add3_u32 v22, v22, v23, v8
v_cmp_ne_u32 vcc, v22, v18
s_cbranch_vccz L_back29z
s_add_u32 s87, s87, 1
s_cmp_lt_u32 s87, 0x8000
s_cbranch_scc1 L_loop30
L_back29z:
s_nop 7
s_branch L_back29
L_slow31:
s_mov_b32 s87, 0
L_loop33:
s_nop 1
s_add_u32 s58, s90, 4096
buffer_load_dwordx4 v[224:227], v1, s[24:27], s58 offen sc1
s_add_u32 s58, s90, 5120
buffer_load_dwordx4 v[228:231], v1, s[24:27], s58 offen sc1
s_add_u32 s58, s90, 6144
buffer_load_dwordx4 v[232:235], v1, s[24:27], s58 offen sc1
s_add_u32 s58, s90, 7168
buffer_load_dwordx4 v[236:239], v1, s[24:27], s58 offen sc1
buffer_load_dword v19, v9, s[24:27], s92 offen offset:256 sc1
s_waitcnt vmcnt(0)
v_add3_u32 v22, v224, v225, v226
v_add3_u32 v22, v22, v227, v228
v_add3_u32 v22, v22, v229, v230
v_add_u32 v22, v22, v231
v_add3_u32 v23, v232, v233, v234
v_add3_u32 v23, v23, v235, v236
v_add3_u32 v23, v23, v237, v238
v_add_u32 v23, v23, v239
s_nop 1
v_permlane32_swap_b32 v22, v23
v_add3_u32 v22, v22, v23, v8
v_cmp_ne_u32 vcc, v22, v19
s_cbranch_vccz L_back32z
s_add_u32 s87, s87, 1
s_cmp_lt_u32 s87, 0x8000
s_cbranch_scc1 L_loop33
L_back32z:
s_nop 7
s_branch L_back32
L_slow38:
s_mov_b32 s87, 0
L_loop40:
s_nop 1
global_load_dword v8, v22, s[80:81] sc1
s_waitcnt vmcnt(0)
v_cmp_eq_u32 vcc, 0, v8
s_cbranch_vccz L_back39z
s_add_u32 s87, s87, 1
s_cmp_lt_u32 s87, 0x8000
s_cbranch_scc1 L_loop40
L_back39z:
s_nop 7
s_branch L_back39
L_slow42:
s_mov_b32 s87, 0
L_loop44:
s_nop 1
s_add_u32 s58, s83, s62
buffer_load_dwordx4 v[208:211], v241, s[24:27], s58 offen sc1
s_add_u32 s58, s58, 4096
buffer_load_dwordx4 v[216:219], v241, s[24:27], s58 offen sc1
s_waitcnt vmcnt(0)
v_min3_u32 v212, v209, v211, v8
v_max3_u32 v213, v209, v211, v8
v_min3_u32 v212, v217, v219, v212
v_max3_u32 v213, v217, v219, v213
v_cmp_ne_u32 vcc, v212, v213
s_cbranch_vccz L_back43z
s_add_u32 s87, s87, 1
s_cmp_lt_u32 s87, 0x8000
s_cbranch_scc1 L_loop44
L_back43z:
s_nop 7
s_branch L_back43
L_slow45:
s_mov_b32 s87, 0
L_loop47:
s_nop 1
s_add_u32 s58, s62, 16384
buffer_load_dwordx4 v[224:227], v241, s[24:27], s58 offen sc1
s_add_u32 s58, s58, 4096
buffer_load_dwordx4 v[232:235], v241, s[24:27], s58 offen sc1
s_waitcnt vmcnt(0)
v_min3_u32 v228, v225, v227, v8
v_max3_u32 v229, v225, v227, v8
v_min3_u32 v228, v233, v235, v228
v_max3_u32 v229, v233, v235, v229
v_cmp_ne_u32 vcc, v228, v229
s_cbranch_vccz L_back46z
s_add_u32 s87, s87, 1
s_cmp_lt_u32 s87, 0x8000
s_cbranch_scc1 L_loop47
L_back46z:
s_nop 7
s_branch L_back46
L_slow49:
s_mov_b32 s87, 0
L_loop51:
s_nop 1
buffer_load_dwordx4 v[28:31], v23, s[24:27], s63 offen sc1
s_waitcnt vmcnt(0)
v_min3_u32 v22, v29, v31, v8
v_max3_u32 v13, v29, v31, v8
v_cmp_ne_u32 vcc, v22, v13
s_cbranch_vccz L_back50z
s_add_u32 s87, s87, 1
s_cmp_lt_u32 s87, 0x8000
s_cbranch_scc1 L_loop51
L_back50z:
s_nop 7
s_branch L_back50
L_slow54:
s_mov_b32 s87, 0
L_loop56:
s_nop 1
s_sub_u32 s58, s85, 65536
buffer_load_dwordx4 v[96:99], v1, s[36:39], s58 offen offset:0 sc1
buffer_load_dwordx4 v[100:103], v1, s[36:39], s58 offen offset:1024 sc1
buffer_load_dwordx4 v[104:107], v1, s[36:39], s58 offen offset:2048 sc1
buffer_load_dwordx4 v[108:111], v1, s[36:39], s58 offen offset:3072 sc1
s_sub_u32 s58, s86, 4096
buffer_load_dword v120, v9, s[36:39], s58 offen sc1
s_waitcnt vmcnt(0)
v_sub_u32 v121, v120, v8
v_add3_u32 v122, v96, v97, v98
v_add3_u32 v122, v122, v99, v100
v_add3_u32 v122, v122, v101, v102
v_add3_u32 v122, v122, v103, v104
v_add3_u32 v122, v122, v105, v106
v_add3_u32 v122, v122, v107, v108
v_add3_u32 v122, v122, v109, v110
v_add_u32 v122, v122, v111
v_cmp_ne_u32 vcc, v121, v122
s_cmp_lg_u32 s38, 0
s_cselect_b64 vcc, vcc, 0
s_cbranch_vccz L_back55z
s_add_u32 s87, s87, 1
s_cmp_lt_u32 s87, 0x8000
s_cbranch_scc1 L_loop56
L_back55z:
s_nop 7
s_branch L_back55
L_slow58:
s_mov_b32 s87, 0
L_loop60:
s_nop 1
buffer_load_dwordx4 v[240:243], v1, s[24:27], s61 offen sc1
buffer_load_dword v248, v9, s[24:27], s61 offen offset:1024 sc1
s_waitcnt vmcnt(0)
v_sub_u32 v250, v248, v8
v_add3_u32 v251, v240, v241, v242
v_add_u32 v251, v251, v243
v_cmp_ne_u32 vcc, v250, v251
s_cbranch_vccz L_back59z
s_add_u32 s87, s87, 1
s_cmp_lt_u32 s87, 0x8000
s_cbranch_scc1 L_loop60
L_back59z:
s_nop 7
s_branch L_back59
L_slow61:
s_mov_b32 s87, 0
L_loop63:
s_nop 1
s_add_u32 s58, s90, 8192
buffer_load_dwordx4 v[144:147], v1, s[24:27], s58 offen sc1
s_add_u32 s58, s90, 9216
buffer_load_dwordx4 v[148:151], v1, s[24:27], s58 offen sc1
s_add_u32 s58, s90, 10240
buffer_load_dwordx4 v[152:155], v1, s[24:27], s58 offen sc1
s_add_u32 s58, s90, 11264
buffer_load_dwordx4 v[156:159], v1, s[24:27], s58 offen sc1
buffer_load_dword v244, v9, s[24:27], s92 offen offset:512 sc1
s_add_u32 s58, s90, 12288
buffer_load_dwordx4 v[160:163], v1, s[24:27], s58 offen sc1
s_add_u32 s58, s90, 13312
buffer_load_dwordx4 v[164:167], v1, s[24:27], s58 offen sc1
s_add_u32 s58, s90, 14336
buffer_load_dwordx4 v[168:171], v1, s[24:27], s58 offen sc1
s_add_u32 s58, s90, 15360
buffer_load_dwordx4 v[172:175], v1, s[24:27], s58 offen sc1
buffer_load_dword v245, v9, s[24:27], s92 offen offset:768 sc1
s_waitcnt vmcnt(0)
v_add3_u32 v22, v144, v145, v146
v_add3_u32 v22, v22, v147, v148
v_add3_u32 v22, v22, v149, v150
v_add_u32 v22, v22, v151
v_add3_u32 v23, v152, v153, v154
v_add3_u32 v23, v23, v155, v156
v_add3_u32 v23, v23, v157, v158
v_add_u32 v23, v23, v159
s_nop 1
v_permlane32_swap_b32 v22, v23
v_add3_u32 v22, v22, v23, v8
v_cmp_ne_u32 vcc, v22, v244
s_cbranch_vccz L_back62z
s_add_u32 s87, s87, 1
s_cmp_lt_u32 s87, 0x8000
s_cbranch_scc1 L_loop63
L_back62z:
s_nop 7
s_branch L_back62
L_slow64:
s_mov_b32 s87, 0
L_loop66:
s_nop 1
s_add_u32 s58, s90, 12288
buffer_load_dwordx4 v[160:163], v1, s[24:27], s58 offen sc1
s_add_u32 s58, s90, 13312
buffer_load_dwordx4 v[164:167], v1, s[24:27], s58 offen sc1
s_add_u32 s58, s90, 14336
buffer_load_dwordx4 v[168:171], v1, s[24:27], s58 offen sc1
s_add_u32 s58, s90, 15360
buffer_load_dwordx4 v[172:175], v1, s[24:27], s58 offen sc1
buffer_load_dword v245, v9, s[24:27], s92 offen offset:768 sc1
s_waitcnt vmcnt(0)
v_add3_u32 v22, v160, v161, v162
v_add3_u32 v22, v22, v163, v164
v_add3_u32 v22, v22, v165, v166
v_add_u32 v22, v22, v167
v_add3_u32 v23, v168, v169, v170
v_add3_u32 v23, v23, v171, v172
v_add3_u32 v23, v23, v173, v174
v_add_u32 v23, v23, v175
s_nop 1
v_permlane32_swap_b32 v22, v23
v_add3_u32 v22, v22, v23, v8
v_cmp_ne_u32 vcc, v22, v245
s_cbranch_vccz L_back65z
s_add_u32 s87, s87, 1
s_cmp_lt_u32 s87, 0x8000
s_cbranch_scc1 L_loop66
L_back65z:
s_nop 7
s_branch L_back65
L_slow67:
s_mov_b32 s87, 0
L_loop69:
s_nop 1
s_add_u32 s58, s90, 16384
buffer_load_dwordx4 v[176:179], v1, s[24:27], s58 offen sc1
s_add_u32 s58, s90, 17408
buffer_load_dwordx4 v[180:183], v1, s[24:27], s58 offen sc1
s_add_u32 s58, s90, 18432
buffer_load_dwordx4 v[184:187], v1, s[24:27], s58 offen sc1
s_add_u32 s58, s90, 19456
buffer_load_dwordx4 v[188:191], v1, s[24:27], s58 offen sc1
buffer_load_dword v246, v9, s[24:27], s92 offen offset:1024 sc1
s_add_u32 s58, s90, 20480
buffer_load_dwordx4 v[192:195], v1, s[24:27], s58 offen sc1
s_add_u32 s58, s90, 21504
buffer_load_dwordx4 v[196:199], v1, s[24:27], s58 offen sc1
s_add_u32 s58, s90, 22528
buffer_load_dwordx4 v[200:203], v1, s[24:27], s58 offen sc1
s_add_u32 s58, s90, 23552
buffer_load_dwordx4 v[204:207], v1, s[24:27], s58 offen sc1
buffer_load_dword v247, v9, s[24:27], s92 offen offset:1280 sc1
s_waitcnt vmcnt(0)
v_add3_u32 v22, v176, v177, v178
v_add3_u32 v22, v22, v179, v180
v_add3_u32 v22, v22, v181, v182
v_add_u32 v22, v22, v183
v_add3_u32 v23, v184, v185, v186
v_add3_u32 v23, v23, v187, v188
v_add3_u32 v23, v23, v189, v190
v_add_u32 v23, v23, v191
s_nop 1
v_permlane32_swap_b32 v22, v23
v_add3_u32 v22, v22, v23, v8
v_cmp_ne_u32 vcc, v22, v246
s_cbranch_vccz L_back68z
s_add_u32 s87, s87, 1
s_cmp_lt_u32 s87, 0x8000
s_cbranch_scc1 L_loop69
L_back68z:
s_nop 7
s_branch L_back68
L_slow70:
s_mov_b32 s87, 0
L_loop72:
s_nop 1
s_add_u32 s58, s90, 20480
buffer_load_dwordx4 v[192:195], v1, s[24:27], s58 offen sc1
s_add_u32 s58, s90, 21504
buffer_load_dwordx4 v[196:199], v1, s[24:27], s58 offen sc1
s_add_u32 s58, s90, 22528
buffer_load_dwordx4 v[200:203], v1, s[24:27], s58 offen sc1
s_add_u32 s58, s90, 23552
buffer_load_dwordx4 v[204:207], v1, s[24:27], s58 offen sc1
buffer_load_dword v247, v9, s[24:27], s92 offen offset:1280 sc1
s_waitcnt vmcnt(0)
v_add3_u32 v22, v192, v193, v194
v_add3_u32 v22, v22, v195, v196
v_add3_u32 v22, v22, v197, v198
v_add_u32 v22, v22, v199
v_add3_u32 v23, v200, v201, v202
v_add3_u32 v23, v23, v203, v204
v_add3_u32 v23, v23, v205, v206
v_add_u32 v23, v23, v207
s_nop 1
v_permlane32_swap_b32 v22, v23
v_add3_u32 v22, v22, v23, v8
v_cmp_ne_u32 vcc, v22, v247
s_cbranch_vccz L_back71z
s_add_u32 s87, s87, 1
s_cmp_lt_u32 s87, 0x8000
s_cbranch_scc1 L_loop72
L_back71z:
s_nop 7
s_branch L_back71
L_slow73:
s_mov_b32 s87, 0
L_loop75:
s_nop 1
s_add_u32 s58, s90, 24576
buffer_load_dwordx4 v[208:211], v1, s[24:27], s58 offen sc1
s_add_u32 s58, s90, 25600
buffer_load_dwordx4 v[212:215], v1, s[24:27], s58 offen sc1
buffer_load_dword v248, v9, s[24:27], s92 offen offset:1536 sc1
s_add_u32 s58, s90, 26624
buffer_load_dwordx4 v[216:219], v1, s[24:27], s58 offen sc1
s_add_u32 s58, s90, 27648
buffer_load_dwordx4 v[220:223], v1, s[24:27], s58 offen sc1
buffer_load_dword v249, v9, s[24:27], s92 offen offset:1792 sc1
s_waitcnt vmcnt(0)
v_add3_u32 v22, v208, v209, v210
v_add_u32 v22, v22, v211
v_add3_u32 v23, v212, v213, v214
v_add_u32 v23, v23, v215
s_nop 1
v_permlane32_swap_b32 v22, v23
v_add3_u32 v22, v22, v23, v8
v_cmp_ne_u32 vcc, v22, v248
s_cbranch_vccz L_back74z
s_add_u32 s87, s87, 1
s_cmp_lt_u32 s87, 0x8000
s_cbranch_scc1 L_loop75
L_back74z:
s_nop 7
s_branch L_back74
L_slow76:
s_mov_b32 s87, 0
L_loop78:
s_nop 1
s_add_u32 s58, s90, 26624
buffer_load_dwordx4 v[216:219], v1, s[24:27], s58 offen sc1
s_add_u32 s58, s90, 27648
buffer_load_dwordx4 v[220:223], v1, s[24:27], s58 offen sc1
buffer_load_dword v249, v9, s[24:27], s92 offen offset:1792 sc1
s_waitcnt vmcnt(0)
v_add3_u32 v22, v216, v217, v218
v_add_u32 v22, v22, v219
v_add3_u32 v23, v220, v221, v222
v_add_u32 v23, v23, v223
s_nop 1
v_permlane32_swap_b32 v22, v23
v_add3_u32 v22, v22, v23, v8
v_cmp_ne_u32 vcc, v22, v249
s_cbranch_vccz L_back77z
s_add_u32 s87, s87, 1
s_cmp_lt_u32 s87, 0x8000
s_cbranch_scc1 L_loop78
L_back77z:
s_nop 7
s_branch L_back77
L_slow79:
s_mov_b32 s87, 0
L_loop81:
s_nop 1
s_add_u32 s58, s90, 28672
buffer_load_dwordx4 v[224:227], v1, s[24:27], s58 offen sc1
s_add_u32 s58, s90, 29696
buffer_load_dwordx4 v[228:231], v1, s[24:27], s58 offen sc1
s_add_u32 s58, s90, 30720
buffer_load_dwordx4 v[232:235], v1, s[24:27], s58 offen sc1
s_add_u32 s58, s90, 31744
buffer_load_dwordx4 v[236:239], v1, s[24:27], s58 offen sc1
buffer_load_dword v250, v9, s[24:27], s92 offen offset:2048 sc1
s_add_u32 s58, s90, 32768
buffer_load_dwordx4 v[144:147], v1, s[24:27], s58 offen sc1
s_add_u32 s58, s90, 33792
buffer_load_dwordx4 v[148:151], v1, s[24:27], s58 offen sc1
s_add_u32 s58, s90, 34816
buffer_load_dwordx4 v[152:155], v1, s[24:27], s58 offen sc1
s_add_u32 s58, s90, 35840
buffer_load_dwordx4 v[156:159], v1, s[24:27], s58 offen sc1
buffer_load_dword v251, v9, s[24:27], s92 offen offset:2304 sc1
s_waitcnt vmcnt(0)
v_add3_u32 v22, v224, v225, v226
v_add3_u32 v22, v22, v227, v228
v_add3_u32 v22, v22, v229, v230
v_add_u32 v22, v22, v231
v_add3_u32 v23, v232, v233, v234
v_add3_u32 v23, v23, v235, v236
v_add3_u32 v23, v23, v237, v238
v_add_u32 v23, v23, v239
s_nop 1
v_permlane32_swap_b32 v22, v23
v_add3_u32 v22, v22, v23, v8
v_cmp_ne_u32 vcc, v22, v250
s_cbranch_vccz L_back80z
s_add_u32 s87, s87, 1
s_cmp_lt_u32 s87, 0x8000
s_cbranch_scc1 L_loop81
L_back80z:
s_nop 7
s_branch L_back80
L_slow82:
s_mov_b32 s87, 0
L_loop84:
s_nop 1
s_add_u32 s58, s90, 32768
buffer_load_dwordx4 v[144:147], v1, s[24:27], s58 offen sc1
s_add_u32 s58, s90, 33792
buffer_load_dwordx4 v[148:151], v1, s[24:27], s58 offen sc1
s_add_u32 s58, s90, 34816
buffer_load_dwordx4 v[152:155], v1, s[24:27], s58 offen sc1
s_add_u32 s58, s90, 35840
buffer_load_dwordx4 v[156:159], v1, s[24:27], s58 offen sc1
buffer_load_dword v251, v9, s[24:27], s92 offen offset:2304 sc1
s_waitcnt vmcnt(0)
v_add3_u32 v22, v144, v145, v146
v_add3_u32 v22, v22, v147, v148
v_add3_u32 v22, v22, v149, v150
v_add_u32 v22, v22, v151
v_add3_u32 v23, v152, v153, v154
v_add3_u32 v23, v23, v155, v156
v_add3_u32 v23, v23, v157, v158
v_add_u32 v23, v23, v159
s_nop 1
v_permlane32_swap_b32 v22, v23
v_add3_u32 v22, v22, v23, v8
v_cmp_ne_u32 vcc, v22, v251
s_cbranch_vccz L_back83z
s_add_u32 s87, s87, 1
s_cmp_lt_u32 s87, 0x8000
s_cbranch_scc1 L_loop84
L_back83z:
s_nop 7
s_branch L_back83
L_slow87:
s_mov_b32 s87, 0
L_loop89:
s_nop 1
s_add_u32 s58, s90, 0
buffer_load_dwordx4 v[208:211], v1, s[24:27], s58 offen sc1
s_add_u32 s58, s90, 1024
buffer_load_dwordx4 v[212:215], v1, s[24:27], s58 offen sc1
s_add_u32 s58, s90, 2048
buffer_load_dwordx4 v[216:219], v1, s[24:27], s58 offen sc1
s_add_u32 s58, s90, 3072
buffer_load_dwordx4 v[220:223], v1, s[24:27], s58 offen sc1
buffer_load_dword v18, v9, s[24:27], s92 offen offset:0 sc1
s_add_u32 s58, s90, 4096
buffer_load_dwordx4 v[224:227], v1, s[24:27], s58 offen sc1
s_add_u32 s58, s90, 5120
buffer_load_dwordx4 v[228:231], v1, s[24:27], s58 offen sc1
s_add_u32 s58, s90, 6144
buffer_load_dwordx4 v[232:235], v1, s[24:27], s58 offen sc1
s_add_u32 s58, s90, 7168
buffer_load_dwordx4 v[236:239], v1, s[24:27], s58 offen sc1
buffer_load_dword v19, v9, s[24:27], s92 offen offset:256 sc1
s_waitcnt vmcnt(0)
v_add3_u32 v22, v208, v209, v210
v_add3_u32 v22, v22, v211, v212
v_add3_u32 v22, v22, v213, v214
v_add_u32 v22, v22, v215
v_add3_u32 v23, v216, v217, v218
v_add3_u32 v23, v23, v219, v220
v_add3_u32 v23, v23, v221, v222
v_add_u32 v23, v23, v223
s_nop 1
v_permlane32_swap_b32 v22, v23
v_add3_u32 v22, v22, v23, v8
v_cmp_ne_u32 vcc, v22, v18
s_cbranch_vccz L_back88z
s_add_u32 s87, s87, 1
s_cmp_lt_u32 s87, 0x8000
s_cbranch_scc1 L_loop89
L_back88z:
s_nop 7
s_branch L_back88
L_slow90:
s_mov_b32 s87, 0
L_loop92:
s_nop 1
s_add_u32 s58, s90, 4096
buffer_load_dwordx4 v[224:227], v1, s[24:27], s58 offen sc1
s_add_u32 s58, s90, 5120
buffer_load_dwordx4 v[228:231], v1, s[24:27], s58 offen sc1
s_add_u32 s58, s90, 6144
buffer_load_dwordx4 v[232:235], v1, s[24:27], s58 offen sc1
s_add_u32 s58, s90, 7168
buffer_load_dwordx4 v[236:239], v1, s[24:27], s58 offen sc1
buffer_load_dword v19, v9, s[24:27], s92 offen offset:256 sc1
s_waitcnt vmcnt(0)
v_add3_u32 v22, v224, v225, v226
v_add3_u32 v22, v22, v227, v228
v_add3_u32 v22, v22, v229, v230
v_add_u32 v22, v22, v231
v_add3_u32 v23, v232, v233, v234
v_add3_u32 v23, v23, v235, v236
v_add3_u32 v23, v23, v237, v238
v_add_u32 v23, v23, v239
s_nop 1
v_permlane32_swap_b32 v22, v23
v_add3_u32 v22, v22, v23, v8
v_cmp_ne_u32 vcc, v22, v19
s_cbranch_vccz L_back91z
s_add_u32 s87, s87, 1
s_cmp_lt_u32 s87, 0x8000
s_cbranch_scc1 L_loop92
L_back91z:
s_nop 7
s_branch L_back91
L_slow97:
s_mov_b32 s87, 0
L_loop99:
s_nop 1
global_load_dword v8, v22, s[80:81] sc1
s_waitcnt vmcnt(0)
v_cmp_eq_u32 vcc, 0, v8
s_cbranch_vccz L_back98z
s_add_u32 s87, s87, 1
s_cmp_lt_u32 s87, 0x8000
s_cbranch_scc1 L_loop99
L_back98z:
s_nop 7
s_branch L_back98
L_slow101:
s_mov_b32 s87, 0
L_loop103:
s_nop 1
s_add_u32 s58, s83, s62
buffer_load_dwordx4 v[208:211], v241, s[24:27], s58 offen sc1
s_add_u32 s58, s58, 4096
buffer_load_dwordx4 v[216:219], v241, s[24:27], s58 offen sc1
s_waitcnt vmcnt(0)
v_min3_u32 v212, v209, v211, v8
v_max3_u32 v213, v209, v211, v8
v_min3_u32 v212, v217, v219, v212
v_max3_u32 v213, v217, v219, v213
v_cmp_ne_u32 vcc, v212, v213
s_cbranch_vccz L_back102z
s_add_u32 s87, s87, 1
s_cmp_lt_u32 s87, 0x8000
s_cbranch_scc1 L_loop103
L_back102z:
s_nop 7
s_branch L_back102
L_slow104:
s_mov_b32 s87, 0
L_loop106:
s_nop 1
s_add_u32 s58, s62, 16384
buffer_load_dwordx4 v[224:227], v241, s[24:27], s58 offen sc1
s_add_u32 s58, s58, 4096
buffer_load_dwordx4 v[232:235], v241, s[24:27], s58 offen sc1
s_waitcnt vmcnt(0)
v_min3_u32 v228, v225, v227, v8
v_max3_u32 v229, v225, v227, v8
v_min3_u32 v228, v233, v235, v228
v_max3_u32 v229, v233, v235, v229
v_cmp_ne_u32 vcc, v228, v229
s_cbranch_vccz L_back105z
s_add_u32 s87, s87, 1
s_cmp_lt_u32 s87, 0x8000
s_cbranch_scc1 L_loop106
L_back105z:
s_nop 7
s_branch L_back105
L_slow108:
s_mov_b32 s87, 0
L_loop110:
s_nop 1
buffer_load_dwordx4 v[28:31], v23, s[24:27], s63 offen sc1
s_waitcnt vmcnt(0)
v_min3_u32 v22, v29, v31, v8
v_max3_u32 v13, v29, v31, v8
v_cmp_ne_u32 vcc, v22, v13
s_cbranch_vccz L_back109z
s_add_u32 s87, s87, 1
s_cmp_lt_u32 s87, 0x8000
s_cbranch_scc1 L_loop110
L_back109z:
s_nop 7
s_branch L_back109
L_slow113:
s_mov_b32 s87, 0
L_loop115:
s_nop 1
buffer_load_dwordx4 v[240:243], v1, s[24:27], s61 offen sc1
buffer_load_dword v248, v9, s[24:27], s61 offen offset:1024 sc1
s_waitcnt vmcnt(0)
v_sub_u32 v250, v248, v8
v_add3_u32 v251, v240, v241, v242
v_add_u32 v251, v251, v243
v_cmp_ne_u32 vcc, v250, v251
s_cbranch_vccz L_back114z
s_add_u32 s87, s87, 1
s_cmp_lt_u32 s87, 0x8000
s_cbranch_scc1 L_loop115
L_back114z:
s_nop 7
s_branch L_back114
L_end:
s_endpgm
.section .rodata,"a"
.p2align 6
.amdhsa_kernel parallel_sum__sliding_local_dilated__glu_gated_swiglu__prompt_kernel
  .amdhsa_next_free_vgpr 256
  .amdhsa_next_free_sgpr 102
  .amdhsa_accum_offset 256
  .amdhsa_group_segment_fixed_size 0
  .amdhsa_kernarg_size 80
  .amdhsa_user_sgpr_count 2
  .amdhsa_user_sgpr_kernarg_segment_ptr 1
  .amdhsa_system_sgpr_workgroup_id_x 1
  .amdhsa_float_denorm_mode_32 3
.end_amdhsa_kernel
```
